```python
import torch

def _softmax(x, axis=-1):
    return torch.softmax(x, dim=axis)

def _gelu(x):
    return torch.nn.functional.gelu(x, approximate='tanh')

def _silu(x):
    return torch.nn.functional.silu(x)

def _sigmoid(x):
    return torch.sigmoid(x)

def _layernorm(x, axis=-1, eps=1e-05):
    m = x.mean(dim=axis, keepdim=True)
    v = x.var(dim=axis, keepdim=True, unbiased=False)
    return (x - m) / torch.sqrt(v + eps)

def _scatter_add(tgt, idx, src, axis=0):
    return tgt.clone().index_add_(axis, idx, src)

def _segment_sum(src, seg, n):
    out = torch.zeros((n,) + src.shape[1:], dtype=src.dtype)
    return out.index_add_(0, seg, src)

def _pad(x, pw):
    flat = tuple((v for pair in reversed(pw) for v in pair))
    return torch.nn.functional.pad(x, flat)
kernel_name = 'adaLN_cond__gqa_block_cached__mixer_token_mlp__decode'

def setup_inputs():

    _w = lambda a: (lambda t: t.to(torch.bfloat16) if t.is_floating_point() else t)(torch.as_tensor(a))

    def _A_setup():
        B, Sq, D = (1, 1, 1024)
        Hq, Hkv, Sk, Dh = (32, 4, 65536, 128)
        assert Hq % Hkv == 0, (Hq, Hkv)
        return {'x': _w((lambda *s: torch.randn(*s, dtype=torch.bfloat16) * 0.1)(B, Sq, D)), 'k_cache': _w((lambda *s: torch.randn(*s, dtype=torch.bfloat16) * 3.2)(B, Hkv, Sk, Dh)), 'v_cache': _w((lambda *s: torch.randn(*s, dtype=torch.bfloat16) * 1.6)(B, Hkv, Sk, Dh)), 'wq': _w((lambda *s: torch.randn(*s, dtype=torch.bfloat16) * 3.2)(D, Hq * Dh) * D ** (-0.5)), 'wo': _w((lambda *s: torch.randn(*s, dtype=torch.bfloat16) * 1.6)(Hq * Dh, D) * (Hq * Dh) ** (-0.5))}
    _A_in = _A_setup()

    def _B_setup():
        B, S, D, F = (1, 1, 1024, 3584)
        return {'x': _w((lambda *s: torch.randn(*s, dtype=torch.bfloat16) * 0.1)(B, S, D)), 'w1': _w((lambda *s: torch.randn(*s, dtype=torch.bfloat16) * 1.6)(S, F) * S ** (-0.5)), 'b1': _w((lambda *s: torch.randn(*s, dtype=torch.bfloat16) * 1.6)(F) * 0.02), 'w2': _w((lambda *s: torch.randn(*s, dtype=torch.bfloat16) * 1.6)(F, S) * F ** (-0.5)), 'b2': _w((lambda *s: torch.randn(*s, dtype=torch.bfloat16) * 1.6)(S) * 0.02)}
    _B_in = _B_setup()
    return {'A_x': _A_in['x'], 'A_k_cache': _A_in['k_cache'], 'A_v_cache': _A_in['v_cache'], 'A_wq': _A_in['wq'], 'A_wo': _A_in['wo'], 'B_x': _B_in['x'], 'B_w1': _B_in['w1'], 'B_b1': _B_in['b1'], 'B_w2': _B_in['w2'], 'B_b2': _B_in['b2'], 'c': _w((lambda *s: torch.randn(*s, dtype=torch.bfloat16) * 0.1)(1, 1024) * 8.0), 'w_mod': _w((lambda *s: torch.randn(*s, dtype=torch.bfloat16) * 0.1)(1024, 6 * 1024) * 1024 ** (-0.5) * 8.0)}

def reference(A_x, A_k_cache, A_v_cache, A_wq, A_wo, B_x, B_w1, B_b1, B_w2, B_b2, c, w_mod):

    def _A_ref(x, k_cache, v_cache, wq, wo):
        B, Sq, D = x.shape
        Hq, Dh = (32, 128)
        Hkv = k_cache.shape[1]
        rep = Hq // Hkv
        q = (lambda x, *d: x.permute(*d))((x @ wq).reshape(B, Sq, Hq, Dh), 0, 2, 1, 3)
        k = (lambda x, n, axis: torch.repeat_interleave(x, n, dim=axis))(k_cache, rep, axis=1)
        v = (lambda x, n, axis: torch.repeat_interleave(x, n, dim=axis))(v_cache, rep, axis=1)
        scores = torch.einsum('bhqd,bhkd->bhqk', q, k) * Dh ** (-0.5)
        p = _softmax(scores, axis=-1)
        o = torch.einsum('bhqk,bhkd->bhqd', p, v)
        return (lambda x, *d: x.permute(*d))(o, 0, 2, 1, 3).reshape(B, Sq, Hq * Dh) @ wo

    def _B_ref(x, w1, b1, w2, b2):
        B, S, D = x.shape
        h = _layernorm(x, axis=-1)
        u = torch.einsum('bsd,sf->bdf', h, w1) + b1
        u = _gelu(u)
        y = torch.einsum('bdf,fs->bds', u, w2) + b2
        return (lambda x, *d: x.permute(*d))(y, 0, 2, 1)
    x = A_x
    mod = (_silu(c) @ w_mod).reshape(c.shape[0], 6, 1, -1)
    sa, ca, ga, sb, cb, gb = (mod[:, 0].clone(), mod[:, 1].clone(), mod[:, 2].clone(), mod[:, 3].clone(), mod[:, 4].clone(), mod[:, 5].clone())
    h = _layernorm(x, axis=-1) * (1 + ca) + sa
    x = x + ga * _A_ref(h, A_k_cache, A_v_cache, A_wq, A_wo)
    h = _layernorm(x, axis=-1) * (1 + cb) + sb
    x = x + gb * _B_ref(h, B_w1, B_b1, B_w2, B_b2)
    return x
```

```asm
; @launch grid=(256,1,1) block=(512,1,1) lds=163840
.amdgcn_target "amdgcn-amd-amdhsa--gfx950"
.text
.globl adaLN_cond__gqa_block_cached__mixer_token_mlp__decode_kernel
.p2align 8
.type adaLN_cond__gqa_block_cached__mixer_token_mlp__decode_kernel,@function
adaLN_cond__gqa_block_cached__mixer_token_mlp__decode_kernel:
    s_load_dwordx16 s[16:31], s[0:1], 0
    s_load_dwordx8 s[32:39], s[0:1], 64
    s_load_dwordx4 s[40:43], s[0:1], 96
    s_load_dwordx2 s[44:45], s[0:1], 112
    v_lshrrev_b32 v1, 6, v0
    v_and_b32 v0, 63, v0
    s_lshr_b32 s4, s2, 8
    s_cbranch_scc1 L_end
    v_readfirstlane_b32 s3, v1
    s_mov_b32 s51, 0x20000
    s_lshr_b32 s4, s2, 6
    s_and_b32 s5, s2, 63
    s_cmp_ge_u32 s3, 4
    s_cbranch_scc1 L_service
    s_getpc_b64 s[70:71]
L_pcref:
    s_bfe_u32 s7, s2, 0x40003
    s_lshl2_add_u32 s8, s7, s3
    s_lshl_b32 s8, s8, 9
    v_lshl_add_u32 v1, v0, 7, s8
    v_min_u32 v1, L_end-L_pcref, v1
    s_mov_b64 exec, 15
    global_load_dword v12, v1, s[70:71]
    s_mov_b64 exec, -1
    s_lshl2_add_u32 s9, s5, s3
    s_lshl_b32 s9, s9, 13
    s_lshl_b32 s8, s4, 24
    s_add_u32 s9, s9, s8
    s_lshl_b32 s12, s3, 15
    v_lshrrev_b32 v13, 4, v0
    v_and_b32 v14, 15, v0
    v_lshlrev_b32 v15, 2, v13
    v_xor_b32 v1, v14, v15
    v_lshlrev_b32 v1, 4, v1
    v_lshl_add_u32 v1, v13, 8, v1
    v_xor_b32 v2, 16, v1
    v_xor_b32 v3, 32, v1
    v_xor_b32 v4, 48, v1
    s_brev_b32 s50, 32
    s_waitcnt lgkmcnt(0)
    s_mov_b64 s[48:49], s[18:19]
    s_add_u32 m0, s12, 0
    s_add_u32 s10, s9, 0
    buffer_load_dwordx4 v1, s[48:51], s10 offen offset:0 nt lds
    buffer_load_dwordx4 v2, s[48:51], s10 offen offset:1024 nt lds
    s_branch L_attn2
L_service:
    s_sub_u32 s3, s3, 4
    s_cmp_ge_u32 s3, 2
    s_cbranch_scc1 L_tabwaves
    s_and_b32 s55, s2, 4
    s_lshr_b32 s55, s55, 1
    s_lshr_b32 s53, s2, 3
    s_and_b32 s8, s2, 3
    s_lshl2_add_u32 s53, s53, s8
    s_cmp_eq_u32 s3, 1
    s_cselect_b32 s65, 1, s55
    s_setprio 3
L_unit:
    s_and_b32 s67, s53, 63
    s_add_u32 s67, s67, 32
    s_lshr_b32 s69, s53, 6
    s_add_u32 s69, s69, s55
    s_movk_i32 s66, 0x3000
    s_and_b32 s8, s53, 31
    s_lshr_b32 s10, s53, 5
    s_cmp_eq_u32 s65, 0
    s_cselect_b32 s67, s8, s67
    s_cselect_b32 s69, s10, s69
    s_add_u32 s68, s5, 96
    s_cmp_eq_u32 s65, 1
    s_cselect_b32 s68, s68, s67
    s_cselect_b32 s67, s5, s67
    s_cselect_b32 s66, 0x2000, s66
    s_cselect_b32 s69, s4, s69
    s_lshl_b32 s50, s66, 10
    s_lshl_b32 s67, s67, 7
    v_and_b32 v1, 56, v0
    v_mul_u32_u24 v1, s66, v1
    v_and_b32 v2, 7, v0
    v_lshl_add_u32 v1, v2, 4, v1
    s_cmp_eq_u32 s65, 3
    s_cselect_b32 s8, 7, 8
    s_lshl_b32 s54, s69, s8
    s_mul_i32 s10, s54, s66
    s_add_u32 s10, s10, s67
    s_mul_i32 s11, s66, 57
    s_lshl_b32 s8, s54, 1
    v_lshl_add_u32 v2, v0, 2, s8
    s_waitcnt lgkmcnt(0)
    s_mov_b64 s[48:49], s[38:39]
    s_mov_b64 s[70:71], s[36:37]
    s_cmp_lg_u32 s65, 1
    s_cbranch_scc1 L_notq
    s_mov_b64 s[48:49], s[22:23]
    s_mov_b64 s[70:71], s[16:17]
    v_lshlrev_b32 v3, 5, v0
    s_barrier
    global_load_dwordx4 v[16:19], v3, s[16:17]
    global_load_dwordx4 v[20:23], v3, s[16:17] offset:16
L_notq:
    global_load_dword v4, v2, s[70:71]
    global_load_dword v5, v2, s[70:71] offset:256
    buffer_load_dwordx4 v[128:131], v1, s[48:51], s10 offen nt
    s_add_u32 s10, s10, s66
    buffer_load_dwordx4 v[132:135], v1, s[48:51], s10 offen nt
    s_add_u32 s10, s10, s66
    buffer_load_dwordx4 v[136:139], v1, s[48:51], s10 offen nt
    s_add_u32 s10, s10, s66
    buffer_load_dwordx4 v[140:143], v1, s[48:51], s10 offen nt
    s_add_u32 s10, s10, s66
    buffer_load_dwordx4 v[144:147], v1, s[48:51], s10 offen nt
    s_add_u32 s10, s10, s66
    buffer_load_dwordx4 v[148:151], v1, s[48:51], s10 offen nt
    s_add_u32 s10, s10, s66
    buffer_load_dwordx4 v[152:155], v1, s[48:51], s10 offen nt
    s_add_u32 s10, s10, s66
    buffer_load_dwordx4 v[156:159], v1, s[48:51], s10 offen nt
    s_add_u32 s10, s10, s11
    s_load_dword s9, s[44:45], 167936
    s_bfe_u32 s7, s2, 0x40003
    s_and_b32 s6, s2, 7
    s_lshr_b32 s8, s2, 7
    s_lshl1_add_u32 s6, s6, s8
    s_mov_b32 s60, 0x05040100
    s_mov_b32 s61, 0x07060302
    s_mov_b32 s62, 0xffff0000
    s_mov_b32 s64, 0x3fb8aa3b
    s_mov_b64 s[56:57], s[44:45]
    s_mov_b32 s58, 0x400000
    s_mov_b32 s59, 0x20000
    v_mov_b32 v13, 131072
    s_cmp_lg_u32 s65, 0
    s_cbranch_scc1 L_norclr
    s_cmp_ge_u32 s53, 56
    s_cbranch_scc1 L_norclr
    s_mul_i32 s8, s53, 256
    s_add_u32 s8, s8, 196608
    s_mov_b64 exec, 1
    buffer_store_dword v0, off, s[56:59], s8 sc1
    s_mov_b64 exec, -1
L_norclr:
    buffer_load_dwordx4 v[160:163], v1, s[48:51], s10 offen nt
    s_add_u32 s10, s10, s66
    buffer_load_dwordx4 v[164:167], v1, s[48:51], s10 offen nt
    s_add_u32 s10, s10, s66
    buffer_load_dwordx4 v[168:171], v1, s[48:51], s10 offen nt
    s_add_u32 s10, s10, s66
    buffer_load_dwordx4 v[172:175], v1, s[48:51], s10 offen nt
    s_add_u32 s10, s10, s66
    buffer_load_dwordx4 v[176:179], v1, s[48:51], s10 offen nt
    s_add_u32 s10, s10, s66
    buffer_load_dwordx4 v[180:183], v1, s[48:51], s10 offen nt
    s_add_u32 s10, s10, s66
    buffer_load_dwordx4 v[184:187], v1, s[48:51], s10 offen nt
    s_add_u32 s10, s10, s66
    buffer_load_dwordx4 v[188:191], v1, s[48:51], s10 offen nt
    s_add_u32 s10, s10, s11
    s_cmp_eq_u32 s65, 3
    s_cbranch_scc1 L_halfl
    buffer_load_dwordx4 v[192:195], v1, s[48:51], s10 offen nt
    s_add_u32 s10, s10, s66
    buffer_load_dwordx4 v[196:199], v1, s[48:51], s10 offen nt
    s_add_u32 s10, s10, s66
    buffer_load_dwordx4 v[200:203], v1, s[48:51], s10 offen nt
    s_add_u32 s10, s10, s66
    buffer_load_dwordx4 v[204:207], v1, s[48:51], s10 offen nt
    s_add_u32 s10, s10, s66
    s_waitcnt vmcnt(19)
    buffer_load_dwordx4 v[208:211], v1, s[48:51], s10 offen nt
    s_add_u32 s10, s10, s66
    s_waitcnt vmcnt(19)
    buffer_load_dwordx4 v[212:215], v1, s[48:51], s10 offen nt
    s_add_u32 s10, s10, s66
    s_waitcnt vmcnt(19)
    buffer_load_dwordx4 v[216:219], v1, s[48:51], s10 offen nt
    s_add_u32 s10, s10, s66
    s_waitcnt vmcnt(19)
    buffer_load_dwordx4 v[220:223], v1, s[48:51], s10 offen nt
    s_add_u32 s10, s10, s11
    s_waitcnt vmcnt(19)
    buffer_load_dwordx4 v[224:227], v1, s[48:51], s10 offen nt
    s_add_u32 s10, s10, s66
    s_waitcnt vmcnt(19)
    buffer_load_dwordx4 v[228:231], v1, s[48:51], s10 offen nt
    s_add_u32 s10, s10, s66
    s_waitcnt vmcnt(19)
    buffer_load_dwordx4 v[232:235], v1, s[48:51], s10 offen nt
    s_add_u32 s10, s10, s66
    s_waitcnt vmcnt(19)
    buffer_load_dwordx4 v[236:239], v1, s[48:51], s10 offen nt
    s_add_u32 s10, s10, s66
    s_waitcnt vmcnt(19)
    buffer_load_dwordx4 v[240:243], v1, s[48:51], s10 offen nt
    s_add_u32 s10, s10, s66
    s_waitcnt vmcnt(19)
    buffer_load_dwordx4 v[244:247], v1, s[48:51], s10 offen nt
    s_add_u32 s10, s10, s66
    s_waitcnt vmcnt(19)
    buffer_load_dwordx4 v[248:251], v1, s[48:51], s10 offen nt
    s_add_u32 s10, s10, s66
    s_waitcnt vmcnt(19)
    buffer_load_dwordx4 v[252:255], v1, s[48:51], s10 offen nt
    s_cmp_eq_u32 s65, 1
    s_cbranch_scc1 L_go
    s_waitcnt vmcnt(16)
    s_barrier
    s_branch L_went
L_halfl:
    s_waitcnt vmcnt(0)
    s_branch L_went
L_go:
    s_waitcnt vmcnt(14)
    s_waitcnt lgkmcnt(0)
    s_mov_b64 exec, 1
    v_mov_b32 v10, 1
    ds_add_u32 v13, v10 offset:32
    s_mov_b64 exec, -1
L_went:
    s_waitcnt lgkmcnt(0)
    s_add_u32 s46, s9, 1
    s_lshl2_add_u32 s47, s68, s69
    s_lshl_b32 s68, s68, 9
    s_mul_i32 s8, s69, 81920
    s_add_u32 s68, s68, s8
    s_add_u32 s68, s68, 262144
    v_lshlrev_b32 v6, 16, v4
    v_and_b32 v7, s62, v4
    v_lshlrev_b32 v8, 16, v5
    v_and_b32 v9, s62, v5
    s_cmp_eq_u32 s65, 1
    s_cbranch_scc1 L_jobq
    v_mul_f32 v24, s64, v6
    v_mul_f32 v25, s64, v7
    v_mul_f32 v26, s64, v8
    v_mul_f32 v27, s64, v9
    v_exp_f32 v24, -v24
    v_exp_f32 v25, -v25
    v_exp_f32 v26, -v26
    v_exp_f32 v27, -v27
    v_add_f32 v24, 1.0, v24
    v_add_f32 v25, 1.0, v25
    v_add_f32 v26, 1.0, v26
    v_add_f32 v27, 1.0, v27
    v_rcp_f32 v24, v24
    v_rcp_f32 v25, v25
    v_rcp_f32 v26, v26
    v_rcp_f32 v27, v27
    v_mul_f32 v6, v6, v24
    v_mul_f32 v7, v7, v25
    v_mul_f32 v8, v8, v26
    v_mul_f32 v9, v9, v27
L_jobcommon:
    v_cvt_pk_bf16_f32 v4, v6, v7
    v_cvt_pk_bf16_f32 v5, v8, v9
    s_lshl_b32 s8, s3, 10
    s_add_u32 s8, s8, 154880
    v_lshl_add_u32 v2, v0, 2, s8
    ds_write2_b32 v2, v4, v5 offset0:0 offset1:64
    v_lshrrev_b32 v3, 4, v0
    v_lshlrev_b32 v3, 1, v3
    v_and_b32 v6, 1, v0
    v_add_u32 v3, v3, v6
    v_lshl_add_u32 v3, v3, 4, s8
    s_waitcnt lgkmcnt(0)
    ds_read_b128 v[32:35], v3 offset:0
    ds_read_b128 v[40:43], v3 offset:128
    ds_read_b128 v[48:51], v3 offset:256
    ds_read_b128 v[56:59], v3 offset:384
    s_waitcnt lgkmcnt(0)
    s_waitcnt vmcnt(24)
    v_perm_b32 v96, v132, v128, s60
    v_perm_b32 v97, v140, v136, s60
    v_perm_b32 v98, v148, v144, s60
    v_perm_b32 v99, v156, v152, s60
    v_perm_b32 v100, v132, v128, s61
    v_perm_b32 v101, v140, v136, s61
    v_perm_b32 v102, v148, v144, s61
    v_perm_b32 v103, v156, v152, s61
    v_mfma_f32_16x16x32_bf16 v[64:67], v[96:99], v[32:35], 0
    v_perm_b32 v104, v133, v129, s60
    v_perm_b32 v105, v141, v137, s60
    v_perm_b32 v106, v149, v145, s60
    v_perm_b32 v107, v157, v153, s60
    v_mfma_f32_16x16x32_bf16 v[68:71], v[100:103], v[32:35], 0
    v_perm_b32 v108, v133, v129, s61
    v_perm_b32 v109, v141, v137, s61
    v_perm_b32 v110, v149, v145, s61
    v_perm_b32 v111, v157, v153, s61
    v_mfma_f32_16x16x32_bf16 v[72:75], v[104:107], v[32:35], 0
    v_perm_b32 v112, v134, v130, s60
    v_perm_b32 v113, v142, v138, s60
    v_perm_b32 v114, v150, v146, s60
    v_perm_b32 v115, v158, v154, s60
    v_mfma_f32_16x16x32_bf16 v[76:79], v[108:111], v[32:35], 0
    v_perm_b32 v116, v134, v130, s61
    v_perm_b32 v117, v142, v138, s61
    v_perm_b32 v118, v150, v146, s61
    v_perm_b32 v119, v158, v154, s61
    v_mfma_f32_16x16x32_bf16 v[80:83], v[112:115], v[32:35], 0
    v_perm_b32 v120, v135, v131, s60
    v_perm_b32 v121, v143, v139, s60
    v_perm_b32 v122, v151, v147, s60
    v_perm_b32 v123, v159, v155, s60
    v_mfma_f32_16x16x32_bf16 v[84:87], v[116:119], v[32:35], 0
    v_perm_b32 v124, v135, v131, s61
    v_perm_b32 v125, v143, v139, s61
    v_perm_b32 v126, v151, v147, s61
    v_perm_b32 v127, v159, v155, s61
    v_mfma_f32_16x16x32_bf16 v[88:91], v[120:123], v[32:35], 0
    s_nop 0
    v_mfma_f32_16x16x32_bf16 v[92:95], v[124:127], v[32:35], 0
    s_waitcnt vmcnt(16)
    v_perm_b32 v96, v164, v160, s60
    v_perm_b32 v97, v172, v168, s60
    v_perm_b32 v98, v180, v176, s60
    v_perm_b32 v99, v188, v184, s60
    v_perm_b32 v100, v164, v160, s61
    v_perm_b32 v101, v172, v168, s61
    v_perm_b32 v102, v180, v176, s61
    v_perm_b32 v103, v188, v184, s61
    v_mfma_f32_16x16x32_bf16 v[64:67], v[96:99], v[40:43], v[64:67]
    v_perm_b32 v104, v165, v161, s60
    v_perm_b32 v105, v173, v169, s60
    v_perm_b32 v106, v181, v177, s60
    v_perm_b32 v107, v189, v185, s60
    v_mfma_f32_16x16x32_bf16 v[68:71], v[100:103], v[40:43], v[68:71]
    v_perm_b32 v108, v165, v161, s61
    v_perm_b32 v109, v173, v169, s61
    v_perm_b32 v110, v181, v177, s61
    v_perm_b32 v111, v189, v185, s61
    v_mfma_f32_16x16x32_bf16 v[72:75], v[104:107], v[40:43], v[72:75]
    v_perm_b32 v112, v166, v162, s60
    v_perm_b32 v113, v174, v170, s60
    v_perm_b32 v114, v182, v178, s60
    v_perm_b32 v115, v190, v186, s60
    v_mfma_f32_16x16x32_bf16 v[76:79], v[108:111], v[40:43], v[76:79]
    v_perm_b32 v116, v166, v162, s61
    v_perm_b32 v117, v174, v170, s61
    v_perm_b32 v118, v182, v178, s61
    v_perm_b32 v119, v190, v186, s61
    v_mfma_f32_16x16x32_bf16 v[80:83], v[112:115], v[40:43], v[80:83]
    v_perm_b32 v120, v167, v163, s60
    v_perm_b32 v121, v175, v171, s60
    v_perm_b32 v122, v183, v179, s60
    v_perm_b32 v123, v191, v187, s60
    v_mfma_f32_16x16x32_bf16 v[84:87], v[116:119], v[40:43], v[84:87]
    v_perm_b32 v124, v167, v163, s61
    v_perm_b32 v125, v175, v171, s61
    v_perm_b32 v126, v183, v179, s61
    v_perm_b32 v127, v191, v187, s61
    v_mfma_f32_16x16x32_bf16 v[88:91], v[120:123], v[40:43], v[88:91]
    s_nop 0
    v_mfma_f32_16x16x32_bf16 v[92:95], v[124:127], v[40:43], v[92:95]
    s_cmp_eq_u32 s65, 3
    s_cbranch_scc1 L_halfg
    s_waitcnt vmcnt(8)
    v_perm_b32 v96, v196, v192, s60
    v_perm_b32 v97, v204, v200, s60
    v_perm_b32 v98, v212, v208, s60
    v_perm_b32 v99, v220, v216, s60
    v_perm_b32 v100, v196, v192, s61
    v_perm_b32 v101, v204, v200, s61
    v_perm_b32 v102, v212, v208, s61
    v_perm_b32 v103, v220, v216, s61
    v_mfma_f32_16x16x32_bf16 v[64:67], v[96:99], v[48:51], v[64:67]
    v_perm_b32 v104, v197, v193, s60
    v_perm_b32 v105, v205, v201, s60
    v_perm_b32 v106, v213, v209, s60
    v_perm_b32 v107, v221, v217, s60
    v_mfma_f32_16x16x32_bf16 v[68:71], v[100:103], v[48:51], v[68:71]
    v_perm_b32 v108, v197, v193, s61
    v_perm_b32 v109, v205, v201, s61
    v_perm_b32 v110, v213, v209, s61
    v_perm_b32 v111, v221, v217, s61
    v_mfma_f32_16x16x32_bf16 v[72:75], v[104:107], v[48:51], v[72:75]
    v_perm_b32 v112, v198, v194, s60
    v_perm_b32 v113, v206, v202, s60
    v_perm_b32 v114, v214, v210, s60
    v_perm_b32 v115, v222, v218, s60
    v_mfma_f32_16x16x32_bf16 v[76:79], v[108:111], v[48:51], v[76:79]
    v_perm_b32 v116, v198, v194, s61
    v_perm_b32 v117, v206, v202, s61
    v_perm_b32 v118, v214, v210, s61
    v_perm_b32 v119, v222, v218, s61
    v_mfma_f32_16x16x32_bf16 v[80:83], v[112:115], v[48:51], v[80:83]
    v_perm_b32 v120, v199, v195, s60
    v_perm_b32 v121, v207, v203, s60
    v_perm_b32 v122, v215, v211, s60
    v_perm_b32 v123, v223, v219, s60
    v_mfma_f32_16x16x32_bf16 v[84:87], v[116:119], v[48:51], v[84:87]
    v_perm_b32 v124, v199, v195, s61
    v_perm_b32 v125, v207, v203, s61
    v_perm_b32 v126, v215, v211, s61
    v_perm_b32 v127, v223, v219, s61
    v_mfma_f32_16x16x32_bf16 v[88:91], v[120:123], v[48:51], v[88:91]
    s_nop 0
    v_mfma_f32_16x16x32_bf16 v[92:95], v[124:127], v[48:51], v[92:95]
    s_waitcnt vmcnt(0)
    v_perm_b32 v96, v228, v224, s60
    v_perm_b32 v97, v236, v232, s60
    v_perm_b32 v98, v244, v240, s60
    v_perm_b32 v99, v252, v248, s60
    v_perm_b32 v100, v228, v224, s61
    v_perm_b32 v101, v236, v232, s61
    v_perm_b32 v102, v244, v240, s61
    v_perm_b32 v103, v252, v248, s61
    v_mfma_f32_16x16x32_bf16 v[64:67], v[96:99], v[56:59], v[64:67]
    v_perm_b32 v104, v229, v225, s60
    v_perm_b32 v105, v237, v233, s60
    v_perm_b32 v106, v245, v241, s60
    v_perm_b32 v107, v253, v249, s60
    v_mfma_f32_16x16x32_bf16 v[68:71], v[100:103], v[56:59], v[68:71]
    v_perm_b32 v108, v229, v225, s61
    v_perm_b32 v109, v237, v233, s61
    v_perm_b32 v110, v245, v241, s61
    v_perm_b32 v111, v253, v249, s61
    v_mfma_f32_16x16x32_bf16 v[72:75], v[104:107], v[56:59], v[72:75]
    v_perm_b32 v112, v230, v226, s60
    v_perm_b32 v113, v238, v234, s60
    v_perm_b32 v114, v246, v242, s60
    v_perm_b32 v115, v254, v250, s60
    v_mfma_f32_16x16x32_bf16 v[76:79], v[108:111], v[56:59], v[76:79]
    v_perm_b32 v116, v230, v226, s61
    v_perm_b32 v117, v238, v234, s61
    v_perm_b32 v118, v246, v242, s61
    v_perm_b32 v119, v254, v250, s61
    v_mfma_f32_16x16x32_bf16 v[80:83], v[112:115], v[56:59], v[80:83]
    v_perm_b32 v120, v231, v227, s60
    v_perm_b32 v121, v239, v235, s60
    v_perm_b32 v122, v247, v243, s60
    v_perm_b32 v123, v255, v251, s60
    v_mfma_f32_16x16x32_bf16 v[84:87], v[116:119], v[56:59], v[84:87]
    v_perm_b32 v124, v231, v227, s61
    v_perm_b32 v125, v239, v235, s61
    v_perm_b32 v126, v247, v243, s61
    v_perm_b32 v127, v255, v251, s61
    v_mfma_f32_16x16x32_bf16 v[88:91], v[120:123], v[56:59], v[88:91]
    s_nop 0
    v_mfma_f32_16x16x32_bf16 v[92:95], v[124:127], v[56:59], v[92:95]
L_halfg:
    v_lshrrev_b32 v3, 5, v0
    v_lshlrev_b32 v3, 8, v3
    v_and_b32 v6, 16, v0
    v_add3_u32 v3, v3, v6, s8
    v_and_b32 v6, 3, v0
    v_lshlrev_b32 v6, 6, v6
    v_bfe_u32 v7, v0, 2, 3
    v_lshl_add_u32 v6, v7, 2, v6
    v_add_u32 v6, s8, v6
    s_mov_b32 exec_lo, 0x00010001
    s_mov_b32 exec_hi, 0x00020002
    ds_write_b128 v3, v[64:67] offset:512
    ds_write_b128 v3, v[68:71] offset:544
    ds_write_b128 v3, v[72:75] offset:576
    ds_write_b128 v3, v[76:79] offset:608
    ds_write_b128 v3, v[80:83] offset:640
    ds_write_b128 v3, v[84:87] offset:672
    ds_write_b128 v3, v[88:91] offset:704
    ds_write_b128 v3, v[92:95] offset:736
    s_mov_b32 exec_lo, -1
    s_mov_b32 exec_hi, 0
    s_waitcnt lgkmcnt(0)
    ds_read2_b32 v[16:17], v6 offset0:128 offset1:136
    ds_read2_b32 v[20:21], v6 offset0:192 offset1:200
    v_lshlrev_b32 v3, 4, v0
    v_mov_b32 v19, s46
    s_lshl_b32 s8, s69, 3
    s_lshl_b32 s52, 0xff, s8
    s_not_b32 s52, s52
    s_cmp_eq_u32 s65, 0
    s_cselect_b32 s52, -1, s52
    s_waitcnt lgkmcnt(0)
    v_add_f32 v18, v17, v21
    v_add_f32 v16, v16, v20
    v_mov_b32 v17, s46
    s_cmp_lg_u32 s65, 3
    s_cbranch_scc1 L_nomrg
    v_add_f32 v16, v16, v28
    v_add_f32 v18, v18, v29
L_nomrg:
    v_mov_b32 v28, v16
    v_mov_b32 v29, v18
    s_cmp_eq_u32 s65, 2
    s_cbranch_scc1 L_nopub
    v_mov_b32 v28, 0
    v_mov_b32 v29, 0
    s_mov_b32 exec_lo, s52
    buffer_store_dwordx4 v[16:19], v3, s[56:59], s68 offen sc1
L_nopub:
    s_mov_b64 exec, -1
    s_bitcmp1_b32 s65, 0
    s_cbranch_scc1 L_unit_done
L_second:
    s_mov_b32 s14, 0
L_spin_74:
    ds_read_b32 v6, v13 offset:28
    s_waitcnt lgkmcnt(0)
    v_readfirstlane_b32 s15, v6
    s_nop 0
    s_cmp_ge_u32 s15, 1
    s_cbranch_scc1 L_spun_75
    s_sleep 4
    s_add_u32 s14, s14, 1
    s_cmp_lt_u32 s14, 262144
    s_cbranch_scc1 L_spin_74
L_spun_75:
    s_mov_b32 s65, 3
    s_branch L_unit
L_jobq:
    v_lshlrev_b32 v96, 16, v16
    v_and_b32 v97, s62, v16
    v_lshlrev_b32 v98, 16, v17
    v_and_b32 v99, s62, v17
    v_lshlrev_b32 v100, 16, v18
    v_and_b32 v101, s62, v18
    v_lshlrev_b32 v102, 16, v19
    v_and_b32 v103, s62, v19
    v_lshlrev_b32 v104, 16, v20
    v_and_b32 v105, s62, v20
    v_lshlrev_b32 v106, 16, v21
    v_and_b32 v107, s62, v21
    v_lshlrev_b32 v108, 16, v22
    v_and_b32 v109, s62, v22
    v_lshlrev_b32 v110, 16, v23
    v_and_b32 v111, s62, v23
    v_add_f32 v24, v96, v97
    v_add_f32 v24, v24, v98
    v_add_f32 v24, v24, v99
    v_add_f32 v24, v24, v100
    v_add_f32 v24, v24, v101
    v_add_f32 v24, v24, v102
    v_add_f32 v24, v24, v103
    v_add_f32 v24, v24, v104
    v_add_f32 v24, v24, v105
    v_add_f32 v24, v24, v106
    v_add_f32 v24, v24, v107
    v_add_f32 v24, v24, v108
    v_add_f32 v24, v24, v109
    v_add_f32 v24, v24, v110
    v_add_f32 v24, v24, v111
    s_nop 1
    v_add_f32_dpp v24, v24, v24 row_ror:8 row_mask:0xf bank_mask:0xf
    s_nop 1
    v_add_f32_dpp v24, v24, v24 row_ror:4 row_mask:0xf bank_mask:0xf
    s_nop 1
    v_add_f32_dpp v24, v24, v24 row_ror:2 row_mask:0xf bank_mask:0xf
    s_nop 1
    v_add_f32_dpp v24, v24, v24 row_ror:1 row_mask:0xf bank_mask:0xf
    v_mov_b32 v25, v24
    s_nop 1
    v_permlane32_swap_b32 v24, v25
    v_add_f32 v24, v24, v25
    v_mov_b32 v25, v24
    s_nop 1
    v_permlane16_swap_b32 v24, v25
    v_add_f32 v24, v24, v25
    v_mul_f32 v24, 0x3a800000, v24
    v_sub_f32 v96, v96, v24
    v_sub_f32 v97, v97, v24
    v_sub_f32 v98, v98, v24
    v_sub_f32 v99, v99, v24
    v_sub_f32 v100, v100, v24
    v_sub_f32 v101, v101, v24
    v_sub_f32 v102, v102, v24
    v_sub_f32 v103, v103, v24
    v_sub_f32 v104, v104, v24
    v_sub_f32 v105, v105, v24
    v_sub_f32 v106, v106, v24
    v_sub_f32 v107, v107, v24
    v_sub_f32 v108, v108, v24
    v_sub_f32 v109, v109, v24
    v_sub_f32 v110, v110, v24
    v_sub_f32 v111, v111, v24
    v_mul_f32 v26, v96, v96
    v_fmac_f32 v26, v97, v97
    v_fmac_f32 v26, v98, v98
    v_fmac_f32 v26, v99, v99
    v_fmac_f32 v26, v100, v100
    v_fmac_f32 v26, v101, v101
    v_fmac_f32 v26, v102, v102
    v_fmac_f32 v26, v103, v103
    v_fmac_f32 v26, v104, v104
    v_fmac_f32 v26, v105, v105
    v_fmac_f32 v26, v106, v106
    v_fmac_f32 v26, v107, v107
    v_fmac_f32 v26, v108, v108
    v_fmac_f32 v26, v109, v109
    v_fmac_f32 v26, v110, v110
    v_fmac_f32 v26, v111, v111
    s_nop 1
    v_add_f32_dpp v26, v26, v26 row_ror:8 row_mask:0xf bank_mask:0xf
    s_nop 1
    v_add_f32_dpp v26, v26, v26 row_ror:4 row_mask:0xf bank_mask:0xf
    s_nop 1
    v_add_f32_dpp v26, v26, v26 row_ror:2 row_mask:0xf bank_mask:0xf
    s_nop 1
    v_add_f32_dpp v26, v26, v26 row_ror:1 row_mask:0xf bank_mask:0xf
    v_mov_b32 v25, v26
    s_nop 1
    v_permlane32_swap_b32 v26, v25
    v_add_f32 v26, v26, v25
    v_mov_b32 v25, v26
    s_nop 1
    v_permlane16_swap_b32 v26, v25
    v_add_f32 v26, v26, v25
    v_mul_f32 v26, 0x3a800000, v26
    v_cvt_pk_bf16_f32 v24, 0, v24
    v_cvt_pk_bf16_f32 v26, 0, v26
    v_add_f32 v26, 0x3727c5ac, v26
    v_cvt_pk_bf16_f32 v26, 0, v26
    v_sqrt_f32 v26, v26
    s_nop 0
    v_cvt_pk_bf16_f32 v26, 0, v26
    v_rcp_f32 v26, v26
    v_sub_f32 v6, v6, v24
    v_sub_f32 v7, v7, v24
    v_sub_f32 v8, v8, v24
    v_sub_f32 v9, v9, v24
    v_cvt_pk_bf16_f32 v6, 0, v6
    v_cvt_pk_bf16_f32 v7, 0, v7
    v_cvt_pk_bf16_f32 v8, 0, v8
    v_cvt_pk_bf16_f32 v9, 0, v9
    v_mul_f32 v6, v6, v26
    v_mul_f32 v7, v7, v26
    v_mul_f32 v8, v8, v26
    v_mul_f32 v9, v9, v26
    v_cvt_pk_bf16_f32 v6, 0, v6
    v_cvt_pk_bf16_f32 v7, 0, v7
    v_cvt_pk_bf16_f32 v8, 0, v8
    v_cvt_pk_bf16_f32 v9, 0, v9
    v_lshlrev_b32 v3, 2, v2
    s_mov_b32 s72, 262144
    s_mov_b32 s73, 344064
    s_mov_b32 s74, 425984
    s_mov_b32 s75, 507904
    s_mov_b32 s76, 270336
    s_mov_b32 s77, 352256
    s_mov_b32 s78, 434176
    s_mov_b32 s79, 516096
    s_waitcnt vmcnt(0)
    s_mov_b32 s14, 0
L_spin_76:
    ds_read_b32 v10, v13 offset:12
    s_waitcnt lgkmcnt(0)
    v_readfirstlane_b32 s15, v10
    s_nop 0
    s_cmp_ge_u32 s15, 4
    s_cbranch_scc1 L_spun_77
    s_sleep 1
    s_add_u32 s14, s14, 1
    s_cmp_lt_u32 s14, 262144
    s_cbranch_scc1 L_spin_76
L_spun_77:
    s_mov_b32 s14, 0
L_tg_78:
    buffer_load_dwordx4 v[16:19], v3, s[56:59], s72 offen offset:0 sc1
    buffer_load_dwordx4 v[32:35], v3, s[56:59], s72 offen offset:1024 sc1
    buffer_load_dwordx4 v[20:23], v3, s[56:59], s73 offen offset:0 sc1
    buffer_load_dwordx4 v[36:39], v3, s[56:59], s73 offen offset:1024 sc1
    buffer_load_dwordx4 v[24:27], v3, s[56:59], s74 offen offset:0 sc1
    buffer_load_dwordx4 v[40:43], v3, s[56:59], s74 offen offset:1024 sc1
    buffer_load_dwordx4 v[28:31], v3, s[56:59], s75 offen offset:0 sc1
    buffer_load_dwordx4 v[44:47], v3, s[56:59], s75 offen offset:1024 sc1
    buffer_load_dwordx4 v[48:51], v3, s[56:59], s76 offen offset:0 sc1
    buffer_load_dwordx4 v[64:67], v3, s[56:59], s76 offen offset:1024 sc1
    buffer_load_dwordx4 v[52:55], v3, s[56:59], s77 offen offset:0 sc1
    buffer_load_dwordx4 v[68:71], v3, s[56:59], s77 offen offset:1024 sc1
    buffer_load_dwordx4 v[56:59], v3, s[56:59], s78 offen offset:0 sc1
    buffer_load_dwordx4 v[72:75], v3, s[56:59], s78 offen offset:1024 sc1
    buffer_load_dwordx4 v[60:63], v3, s[56:59], s79 offen offset:0 sc1
    buffer_load_dwordx4 v[76:79], v3, s[56:59], s79 offen offset:1024 sc1
    s_waitcnt vmcnt(0)
    v_min_u32 v10, v17, v19
    v_max_u32 v11, v17, v19
    v_min3_u32 v10, v33, v35, v10
    v_max3_u32 v11, v33, v35, v11
    v_min3_u32 v10, v21, v23, v10
    v_max3_u32 v11, v21, v23, v11
    v_min3_u32 v10, v37, v39, v10
    v_max3_u32 v11, v37, v39, v11
    v_min3_u32 v10, v25, v27, v10
    v_max3_u32 v11, v25, v27, v11
    v_min3_u32 v10, v41, v43, v10
    v_max3_u32 v11, v41, v43, v11
    v_min3_u32 v10, v29, v31, v10
    v_max3_u32 v11, v29, v31, v11
    v_min3_u32 v10, v45, v47, v10
    v_max3_u32 v11, v45, v47, v11
    v_min3_u32 v10, v49, v51, v10
    v_max3_u32 v11, v49, v51, v11
    v_min3_u32 v10, v65, v67, v10
    v_max3_u32 v11, v65, v67, v11
    v_min3_u32 v10, v53, v55, v10
    v_max3_u32 v11, v53, v55, v11
    v_min3_u32 v10, v69, v71, v10
    v_max3_u32 v11, v69, v71, v11
    v_min3_u32 v10, v57, v59, v10
    v_max3_u32 v11, v57, v59, v11
    v_min3_u32 v10, v73, v75, v10
    v_max3_u32 v11, v73, v75, v11
    v_min3_u32 v10, v61, v63, v10
    v_max3_u32 v11, v61, v63, v11
    v_min3_u32 v10, v77, v79, v10
    v_max3_u32 v11, v77, v79, v11
    v_cmp_ne_u32 vcc, s46, v10
    v_cmp_ne_u32 s[70:71], s46, v11
    s_nop 0
    s_or_b64 vcc, vcc, s[70:71]
    s_cbranch_vccz L_tgok_79
    s_mov_b64 exec, vcc
    s_sleep 2
    s_add_u32 s14, s14, 1
    s_cmp_lt_u32 s14, 262144
    s_cbranch_scc1 L_tg_78
L_tgok_79:
    s_mov_b64 exec, -1
    v_add_f32 v16, v16, v20
    v_add_f32 v24, v24, v28
    v_add_f32 v18, v18, v22
    v_add_f32 v26, v26, v30
    v_add_f32 v96, v16, v24
    v_add_f32 v97, v18, v26
    v_add_f32 v32, v32, v36
    v_add_f32 v40, v40, v44
    v_add_f32 v34, v34, v38
    v_add_f32 v42, v42, v46
    v_add_f32 v98, v32, v40
    v_add_f32 v99, v34, v42
    v_add_f32 v48, v48, v52
    v_add_f32 v56, v56, v60
    v_add_f32 v50, v50, v54
    v_add_f32 v58, v58, v62
    v_add_f32 v100, v48, v56
    v_add_f32 v101, v50, v58
    v_add_f32 v64, v64, v68
    v_add_f32 v72, v72, v76
    v_add_f32 v66, v66, v70
    v_add_f32 v74, v74, v78
    v_add_f32 v102, v64, v72
    v_add_f32 v103, v66, v74
    v_cvt_pk_bf16_f32 v96, 0, v96
    v_cvt_pk_bf16_f32 v97, 0, v97
    v_cvt_pk_bf16_f32 v98, 0, v98
    v_cvt_pk_bf16_f32 v99, 0, v99
    v_cvt_pk_bf16_f32 v100, 0, v100
    v_cvt_pk_bf16_f32 v101, 0, v101
    v_cvt_pk_bf16_f32 v102, 0, v102
    v_cvt_pk_bf16_f32 v103, 0, v103
    v_add_f32 v100, 1.0, v100
    v_add_f32 v101, 1.0, v101
    v_add_f32 v102, 1.0, v102
    v_add_f32 v103, 1.0, v103
    v_cvt_pk_bf16_f32 v100, 0, v100
    v_cvt_pk_bf16_f32 v101, 0, v101
    v_cvt_pk_bf16_f32 v102, 0, v102
    v_cvt_pk_bf16_f32 v103, 0, v103
    v_mul_f32 v6, v6, v100
    v_mul_f32 v7, v7, v101
    v_mul_f32 v8, v8, v102
    v_mul_f32 v9, v9, v103
    v_cvt_pk_bf16_f32 v6, 0, v6
    v_cvt_pk_bf16_f32 v7, 0, v7
    v_cvt_pk_bf16_f32 v8, 0, v8
    v_cvt_pk_bf16_f32 v9, 0, v9
    v_add_f32 v6, v6, v96
    v_add_f32 v7, v7, v97
    v_add_f32 v8, v8, v98
    v_add_f32 v9, v9, v99
    s_branch L_jobcommon
L_unit_done:
    s_cmp_eq_u32 s3, 1
    s_cbranch_scc1 L_lvl2
    s_mov_b32 s14, 0
L_spin_80:
    ds_read_b32 v6, v13 offset:12
    s_waitcnt lgkmcnt(0)
    v_readfirstlane_b32 s15, v6
    s_nop 0
    s_cmp_ge_u32 s15, 12
    s_cbranch_scc1 L_spun_81
    s_sleep 8
    s_add_u32 s14, s14, 1
    s_cmp_lt_u32 s14, 262144
    s_cbranch_scc1 L_spin_80
L_spun_81:
L_lvl2:
    s_waitcnt vmcnt(0)
    v_lshrrev_b32 v1, 3, v0
    s_mov_b32 s8, 81920
    v_mul_lo_u32 v1, v1, s8
    v_and_b32 v2, 7, v0
    v_lshl_add_u32 v1, v2, 4, v1
    s_lshl_b32 s8, s47, 7
    s_add_u32 s8, s8, 262144
    s_mov_b32 exec_lo, s52
    s_mov_b32 exec_hi, 0
    s_mov_b32 s14, 0
L_tg_82:
    buffer_load_dwordx4 v[16:19], v1, s[56:59], s8 offen sc1
    s_waitcnt vmcnt(0)
    v_min_u32 v10, v17, v19
    v_max_u32 v11, v17, v19
    v_cmp_ne_u32 vcc, s46, v10
    v_cmp_ne_u32 s[70:71], s46, v11
    s_nop 0
    s_or_b64 vcc, vcc, s[70:71]
    s_cbranch_vccz L_tgok_83
    s_mov_b64 exec, vcc
    s_sleep 6
    s_add_u32 s14, s14, 1
    s_cmp_lt_u32 s14, 262144
    s_cbranch_scc1 L_tg_82
L_tgok_83:
    s_mov_b64 exec, -1
    s_mov_b64 exec, -1
    v_add_f32_dpp v16, v16, v16 row_ror:8 row_mask:0xf bank_mask:0xf
    v_add_f32_dpp v18, v18, v18 row_ror:8 row_mask:0xf bank_mask:0xf
    v_mov_b32 v20, v16
    v_mov_b32 v22, v18
    s_nop 0
    v_permlane16_swap_b32 v16, v20
    v_permlane16_swap_b32 v18, v22
    v_add_f32 v16, v16, v20
    v_add_f32 v18, v18, v22
    v_cvt_pk_bf16_f32 v16, v16, v18
    s_cmp_eq_u32 s65, 3
    s_cbranch_scc1 L_rest2
    v_lshlrev_b32 v2, 3, v2
    s_lshl_b32 s8, s47, 6
    s_add_u32 s8, s8, 106496
    s_mov_b64 exec, 0xff
    buffer_store_dwordx2 v[16:17], v2, s[56:59], s8 offen sc1
    s_mov_b64 exec, -1
    s_cmp_eq_u32 s65, 0
    s_cbranch_scc1 L_second
    s_waitcnt lgkmcnt(0)
    s_mov_b64 exec, 1
    v_mov_b32 v10, 1
    ds_add_u32 v13, v10 offset:28
    s_mov_b64 exec, -1
    s_mov_b32 s14, 0
L_spin_84:
    ds_read_b32 v6, v13 offset:12
    s_waitcnt lgkmcnt(0)
    v_readfirstlane_b32 s15, v6
    s_nop 0
    s_cmp_ge_u32 s15, 8
    s_cbranch_scc1 L_spun_85
    s_sleep 4
    s_add_u32 s14, s14, 1
    s_cmp_lt_u32 s14, 262144
    s_cbranch_scc1 L_spin_84
L_spun_85:
    s_lshl_b32 s8, s4, 12
    s_add_u32 s8, s8, 131072
    v_lshlrev_b32 v1, 4, v0
    s_mov_b32 s14, 0
L_tg_86:
    buffer_load_dwordx4 v[20:23], v1, s[56:59], s8 offen offset:0 sc1
    buffer_load_dwordx4 v[24:27], v1, s[56:59], s8 offen offset:1024 sc1
    buffer_load_dwordx4 v[28:31], v1, s[56:59], s8 offen offset:2048 sc1
    buffer_load_dwordx4 v[32:35], v1, s[56:59], s8 offen offset:3072 sc1
    s_waitcnt vmcnt(0)
    v_min_u32 v10, v21, v23
    v_max_u32 v11, v21, v23
    v_min3_u32 v10, v25, v27, v10
    v_max3_u32 v11, v25, v27, v11
    v_min3_u32 v10, v29, v31, v10
    v_max3_u32 v11, v29, v31, v11
    v_min3_u32 v10, v33, v35, v10
    v_max3_u32 v11, v33, v35, v11
    v_cmp_ne_u32 vcc, s46, v10
    v_cmp_ne_u32 s[70:71], s46, v11
    s_nop 0
    s_or_b64 vcc, vcc, s[70:71]
    s_cbranch_vccz L_tgok_87
    s_mov_b64 exec, vcc
    s_sleep 6
    s_add_u32 s14, s14, 1
    s_cmp_lt_u32 s14, 262144
    s_cbranch_scc1 L_tg_86
L_tgok_87:
    s_mov_b64 exec, -1
    v_lshrrev_b32 v2, 1, v1
    v_add_u32 v2, 132096, v2
    v_mov_b32 v21, v22
    ds_write_b64 v2, v[20:21] offset:0
    v_mov_b32 v25, v26
    ds_write_b64 v2, v[24:25] offset:512
    v_mov_b32 v29, v30
    ds_write_b64 v2, v[28:29] offset:1024
    v_mov_b32 v33, v34
    ds_write_b64 v2, v[32:33] offset:1536
    s_waitcnt lgkmcnt(0)
    s_mov_b64 exec, 1
    v_mov_b32 v6, 1
    ds_add_u32 v13, v6 offset:4
    s_mov_b64 exec, -1
    s_mov_b32 s14, 0
L_spin_88:
    ds_read_b32 v6, v13 offset:12
    s_waitcnt lgkmcnt(0)
    v_readfirstlane_b32 s15, v6
    s_nop 0
    s_cmp_ge_u32 s15, 16
    s_cbranch_scc1 L_spun_89
    s_sleep 8
    s_add_u32 s14, s14, 1
    s_cmp_lt_u32 s14, 262144
    s_cbranch_scc1 L_spin_88
L_spun_89:
    s_mov_b32 s8, 163840
    s_mov_b32 s14, 0
L_tg_90:
    buffer_load_dwordx4 v[16:19], v1, s[56:59], s8 offen sc1
    s_waitcnt vmcnt(0)
    v_min_u32 v10, v16, v17
    v_max_u32 v11, v16, v17
    v_min3_u32 v10, v18, v19, v10
    v_max3_u32 v11, v18, v19, v11
    v_cmp_ne_u32 vcc, s46, v10
    v_cmp_ne_u32 s[70:71], s46, v11
    s_nop 0
    s_or_b64 vcc, vcc, s[70:71]
    s_cbranch_vccz L_tgok_91
    s_mov_b64 exec, vcc
    s_sleep 16
    s_add_u32 s14, s14, 1
    s_cmp_lt_u32 s14, 262144
    s_cbranch_scc1 L_tg_90
L_tgok_91:
    s_mov_b64 exec, -1
    s_and_b32 s8, s2, 0xc7
    s_cmp_lg_u32 s8, 0
    s_cbranch_scc1 L_staged
    s_mov_b32 s14, 0
L_spin_92:
    ds_read_b32 v6, v13 offset:8
    s_waitcnt lgkmcnt(0)
    v_readfirstlane_b32 s15, v6
    s_nop 0
    s_cmp_ge_u32 s15, 4
    s_cbranch_scc1 L_spun_93
    s_sleep 4
    s_add_u32 s14, s14, 1
    s_cmp_lt_u32 s14, 262144
    s_cbranch_scc1 L_spin_92
L_spun_93:
    s_mov_b32 m0, 134144
    s_nop 0
    global_load_lds_dwordx4 v1, s[16:17]
    global_load_lds_dwordx4 v1, s[16:17] offset:1024
    s_mov_b32 m0, 136192
    s_mov_b32 s8, 0
    buffer_load_dwordx4 v1, s[56:59], s8 offen offset:0 sc1 lds
    buffer_load_dwordx4 v1, s[56:59], s8 offen offset:1024 sc1 lds
    buffer_load_dwordx4 v1, s[56:59], s8 offen offset:2048 sc1 lds
    buffer_load_dwordx4 v1, s[56:59], s8 offen offset:3072 sc1 lds
    s_mov_b32 m0, 140288
    s_mov_b32 s8, 4096
    buffer_load_dwordx4 v1, s[56:59], s8 offen offset:0 sc1 lds
    buffer_load_dwordx4 v1, s[56:59], s8 offen offset:1024 sc1 lds
    buffer_load_dwordx4 v1, s[56:59], s8 offen offset:2048 sc1 lds
    buffer_load_dwordx4 v1, s[56:59], s8 offen offset:3072 sc1 lds
    s_mov_b32 m0, 144384
    s_mov_b32 s8, 32768
    buffer_load_dwordx4 v1, s[56:59], s8 offen offset:0 sc1 lds
    buffer_load_dwordx4 v1, s[56:59], s8 offen offset:1024 sc1 lds
    buffer_load_dwordx4 v1, s[56:59], s8 offen offset:2048 sc1 lds
    buffer_load_dwordx4 v1, s[56:59], s8 offen offset:3072 sc1 lds
    s_mov_b32 m0, 148480
    s_mov_b32 s8, 36864
    buffer_load_dwordx4 v1, s[56:59], s8 offen offset:0 sc1 lds
    buffer_load_dwordx4 v1, s[56:59], s8 offen offset:1024 sc1 lds
    buffer_load_dwordx4 v1, s[56:59], s8 offen offset:2048 sc1 lds
    buffer_load_dwordx4 v1, s[56:59], s8 offen offset:3072 sc1 lds
    s_mov_b32 m0, 152576
    s_mov_b32 s8, 40960
    buffer_load_dwordx4 v1, s[56:59], s8 offen offset:0 sc1 lds
    buffer_load_dwordx4 v1, s[56:59], s8 offen offset:1024 sc1 lds
    s_waitcnt vmcnt(0)
    s_branch L_staged
L_rest2:
    v_lshlrev_b32 v2, 2, v2
    s_lshl_b32 s8, s47, 5
    s_sub_u32 s8, s8, 4096
    s_mov_b64 exec, 0xff
    buffer_store_dword v16, v2, s[56:59], s8 offen sc1
    s_mov_b64 exec, -1
    s_waitcnt vmcnt(0) lgkmcnt(0)
    s_mov_b64 exec, 1
    v_mov_b32 v6, 1
    ds_add_rtn_u32 v6, v13, v6 offset:24
    s_waitcnt lgkmcnt(0)
    v_readfirstlane_b32 s8, v6
    s_nop 0
    s_cmp_lg_u32 s8, 1
    s_cbranch_scc1 L_nodone_94
    s_lshl_b32 s8, s2, 2
    s_add_u32 s8, s8, 163840
    v_mov_b32 v6, s46
    buffer_store_dword v6, off, s[56:59], s8 sc1
L_nodone_94:
    s_mov_b64 exec, -1
    s_mov_b32 s14, 0
L_spin_95:
    ds_read_b32 v6, v13 offset:8
    s_waitcnt lgkmcnt(0)
    v_readfirstlane_b32 s15, v6
    s_nop 0
    s_cmp_ge_u32 s15, 4
    s_cbranch_scc1 L_spun_96
    s_sleep 2
    s_add_u32 s14, s14, 1
    s_cmp_lt_u32 s14, 262144
    s_cbranch_scc1 L_spin_95
L_spun_96:
    v_and_b32 v1, 7, v0
    v_lshlrev_b32 v1, 3, v1
    v_add_u32 v2, 131328, v1
    ds_read_b64 v[16:17], v2 offset:0
    ds_read_b64 v[18:19], v2 offset:64
    ds_read_b64 v[20:21], v2 offset:128
    ds_read_b64 v[22:23], v2 offset:192
    s_waitcnt lgkmcnt(0)
    v_max_f32 v24, v16, v18
    v_max3_f32 v24, v20, v22, v24
    v_sub_f32 v28, v16, v24
    v_sub_f32 v29, v18, v24
    v_sub_f32 v30, v20, v24
    v_sub_f32 v31, v22, v24
    v_mul_f32 v28, s64, v28
    v_mul_f32 v29, s64, v29
    v_mul_f32 v30, s64, v30
    v_mul_f32 v31, s64, v31
    v_exp_f32 v28, v28
    v_exp_f32 v29, v29
    v_exp_f32 v30, v30
    v_exp_f32 v31, v31
    v_mul_f32 v25, v28, v17
    v_fmac_f32 v25, v29, v19
    v_fmac_f32 v25, v30, v21
    v_fmac_f32 v25, v31, v23
    v_mov_b32_dpp v28, v24 quad_perm:[1,1,3,3] row_mask:0xf bank_mask:0xf
    v_mov_b32 v27, s46
    v_mov_b32_dpp v26, v25 quad_perm:[1,1,3,3] row_mask:0xf bank_mask:0xf
    v_cvt_pk_bf16_f32 v24, v24, v28
    s_lshl_b32 s8, s2, 6
    s_add_u32 s8, s8, 65536
    s_mov_b64 exec, 0x55
    buffer_store_dwordx4 v[24:27], v1, s[56:59], s8 offen sc1
    s_mov_b64 exec, -1
    v_and_b32 v2, 3, v0
    v_bfe_u32 v3, v0, 2, 1
    v_lshl_add_u32 v2, v2, 1, v3
    v_bfe_u32 v4, v0, 3, 2
    v_lshlrev_b32 v7, 6, v4
    v_lshl_add_u32 v7, v2, 3, v7
    v_add_u32 v7, v7, v13
    ds_read_b32 v8, v7 offset:256
    v_lshlrev_b32 v7, 2, v4
    v_lshl_add_u32 v7, v2, 4, v7
    v_add_u32 v7, v7, v13
    s_lshl_b32 s10, s4, 12
    s_add_u32 s10, s10, 65536
    v_lshlrev_b32 v1, 4, v0
    s_mov_b32 s14, 0
L_spin_97:
    ds_read_b32 v6, v13 offset:12
    s_waitcnt lgkmcnt(0)
    v_readfirstlane_b32 s15, v6
    s_nop 0
    s_cmp_ge_u32 s15, 20
    s_cbranch_scc1 L_spun_98
    s_sleep 2
    s_add_u32 s14, s14, 1
    s_cmp_lt_u32 s14, 262144
    s_cbranch_scc1 L_spin_97
L_spun_98:
    s_mov_b32 s14, 0
L_tg_99:
    buffer_load_dwordx4 v[32:35], v1, s[56:59], s10 offen offset:0 sc1
    buffer_load_dwordx4 v[36:39], v1, s[56:59], s10 offen offset:1024 sc1
    buffer_load_dwordx4 v[40:43], v1, s[56:59], s10 offen offset:2048 sc1
    buffer_load_dwordx4 v[44:47], v1, s[56:59], s10 offen offset:3072 sc1
    s_waitcnt vmcnt(0)
    v_min_u32 v10, v35, v39
    v_max_u32 v11, v35, v39
    v_min3_u32 v10, v43, v47, v10
    v_max3_u32 v11, v43, v47, v11
    v_cmp_ne_u32 vcc, s46, v10
    v_cmp_ne_u32 s[70:71], s46, v11
    s_nop 0
    s_or_b64 vcc, vcc, s[70:71]
    s_cbranch_vccz L_tgok_100
    s_mov_b64 exec, vcc
    s_sleep 6
    s_add_u32 s14, s14, 1
    s_cmp_lt_u32 s14, 262144
    s_cbranch_scc1 L_tg_99
L_tgok_100:
    s_mov_b64 exec, -1
    v_lshlrev_b32 v16, 16, v32
    v_and_b32 v20, s62, v32
    v_lshlrev_b32 v17, 16, v36
    v_and_b32 v21, s62, v36
    v_lshlrev_b32 v18, 16, v40
    v_and_b32 v22, s62, v40
    v_lshlrev_b32 v19, 16, v44
    v_and_b32 v23, s62, v44
    v_max_f32 v24, v16, v17
    v_max3_f32 v24, v18, v19, v24
    v_max_f32 v25, v20, v21
    v_max3_f32 v25, v22, v23, v25
    v_max_f32_dpp v24, v24, v24 row_ror:8 row_mask:0xf bank_mask:0xf
    s_nop 0
    v_max_f32_dpp v25, v25, v25 row_ror:8 row_mask:0xf bank_mask:0xf
    v_max_f32_dpp v24, v24, v24 row_ror:4 row_mask:0xf bank_mask:0xf
    s_nop 0
    v_max_f32_dpp v25, v25, v25 row_ror:4 row_mask:0xf bank_mask:0xf
    v_mov_b32 v28, v24
    v_mov_b32 v29, v25
    s_nop 0
    v_permlane32_swap_b32 v24, v28
    v_permlane32_swap_b32 v25, v29
    v_max_f32 v24, v24, v28
    v_max_f32 v25, v25, v29
    v_mov_b32 v28, v24
    v_mov_b32 v29, v25
    s_nop 0
    v_permlane16_swap_b32 v24, v28
    v_permlane16_swap_b32 v25, v29
    v_max_f32 v24, v24, v28
    v_max_f32 v25, v25, v29
    v_sub_f32 v16, v16, v24
    v_sub_f32 v17, v17, v24
    v_sub_f32 v18, v18, v24
    v_sub_f32 v19, v19, v24
    v_sub_f32 v20, v20, v25
    v_sub_f32 v21, v21, v25
    v_sub_f32 v22, v22, v25
    v_sub_f32 v23, v23, v25
    v_mul_f32 v16, s64, v16
    v_mul_f32 v17, s64, v17
    v_mul_f32 v18, s64, v18
    v_mul_f32 v19, s64, v19
    v_mul_f32 v20, s64, v20
    v_mul_f32 v21, s64, v21
    v_mul_f32 v22, s64, v22
    v_mul_f32 v23, s64, v23
    v_exp_f32 v16, v16
    v_exp_f32 v17, v17
    v_exp_f32 v18, v18
    v_exp_f32 v19, v19
    v_exp_f32 v20, v20
    v_exp_f32 v21, v21
    v_exp_f32 v22, v22
    v_exp_f32 v23, v23
    v_mul_f32 v26, v16, v33
    v_mul_f32 v27, v20, v34
    v_fmac_f32 v26, v17, v37
    v_fmac_f32 v27, v21, v38
    v_fmac_f32 v26, v18, v41
    v_fmac_f32 v27, v22, v42
    v_fmac_f32 v26, v19, v45
    v_fmac_f32 v27, v23, v46
    s_nop 0
    v_add_f32_dpp v26, v26, v26 row_ror:8 row_mask:0xf bank_mask:0xf
    v_add_f32_dpp v27, v27, v27 row_ror:8 row_mask:0xf bank_mask:0xf
    s_nop 0
    v_add_f32_dpp v26, v26, v26 row_ror:4 row_mask:0xf bank_mask:0xf
    v_add_f32_dpp v27, v27, v27 row_ror:4 row_mask:0xf bank_mask:0xf
    v_mov_b32 v28, v26
    v_mov_b32 v29, v27
    s_nop 0
    v_permlane32_swap_b32 v26, v28
    v_permlane32_swap_b32 v27, v29
    v_add_f32 v26, v26, v28
    v_add_f32 v27, v27, v29
    v_mov_b32 v28, v26
    v_mov_b32 v29, v27
    s_nop 0
    v_permlane16_swap_b32 v26, v28
    v_permlane16_swap_b32 v27, v29
    v_add_f32 v26, v26, v28
    v_add_f32 v27, v27, v29
    v_cmp_eq_u32 vcc, 1, v3
    s_nop 1
    v_cndmask_b32 v24, v24, v25, vcc
    v_cndmask_b32 v26, v26, v27, vcc
    v_rcp_f32 v26, v26
    v_sub_f32 v8, v8, v24
    v_mul_f32 v8, s64, v8
    v_exp_f32 v8, v8
    s_nop 0
    v_mul_f32 v8, v8, v26
    ds_write_b32 v7, v8 offset:512
    s_branch L_staged
L_tabwaves:
    s_waitcnt lgkmcnt(0)
    s_load_dword s9, s[44:45], 167936
    s_bfe_u32 s7, s2, 0x40003
    s_and_b32 s6, s2, 7
    s_lshr_b32 s8, s2, 7
    s_lshl1_add_u32 s6, s6, s8
    s_mov_b32 s60, 0x05040100
    s_mov_b32 s61, 0x07060302
    s_mov_b32 s62, 0xffff0000
    s_mov_b32 s64, 0x3fb8aa3b
    s_mov_b64 s[56:57], s[44:45]
    s_mov_b32 s58, 0x400000
    s_mov_b32 s59, 0x20000
    v_mov_b32 v13, 131072
    s_cmp_eq_u32 s3, 3
    s_cbranch_scc1 L_tabinit
    v_mov_b32 v20, -1
    v_mov_b32 v21, -1
    v_mov_b32 v22, -1
    v_mov_b32 v23, -1
    v_lshrrev_b32 v1, 5, v0
    v_lshlrev_b32 v1, 15, v1
    v_and_b32 v2, 31, v0
    v_lshl_add_u32 v1, v2, 4, v1
    v_lshrrev_b32 v3, 3, v0
    v_lshlrev_b32 v3, 15, v3
    v_and_b32 v2, 7, v0
    v_lshl_add_u32 v3, v2, 4, v3
    s_lshl_b32 s8, s4, 17
    s_lshl_b32 s10, s5, 9
    s_add_u32 s8, s8, s10
    s_add_u32 s8, s8, 1048576
    s_add_u32 s10, s8, 0x10000
    s_lshl_b32 s11, s6, 11
    s_lshl_b32 s14, s7, 7
    s_add_u32 s11, s11, s14
    s_add_u32 s11, s11, 786432
    buffer_store_dwordx4 v[20:23], v1, s[56:59], s8 offen sc1
    buffer_store_dwordx4 v[20:23], v1, s[56:59], s10 offen sc1
    s_mov_b64 exec, 0xff
    buffer_store_dwordx4 v[20:23], v3, s[56:59], s11 offen sc1
    s_mov_b64 exec, -1
L_tabinit:
    s_and_b32 s8, s2, 127
    s_mul_i32 s8, s8, 20
    s_add_u32 s8, s8, 14080
    s_lshr_b32 s10, s2, 7
    s_lshl_b32 s10, s10, 15
    s_add_u32 s8, s8, s10
    v_add_u32 v2, s8, v0
    v_lshlrev_b32 v2, 16, v2
    v_cmp_gt_u32 vcc, 20, v0
    s_nop 1
    v_cndmask_b32 v12, 0, v2, vcc
    s_mov_b32 s65, 0
    v_mov_b32 v239, 0
    s_waitcnt lgkmcnt(0)
    s_add_u32 s46, s9, 1
    s_barrier
L_mlp:
    s_sub_u32 s8, s3, 2
    s_mul_i32 s8, s8, 3584
    v_lshl_add_u32 v1, v0, 3, s8
    global_load_dwordx2 v[56:57], v1, s[28:29]
    global_load_dwordx2 v[58:59], v1, s[30:31]
    global_load_dwordx2 v[60:61], v1, s[32:33]
    s_load_dword s47, s[34:35], 0
    v_readlane_b32 s16, v12, 0
    v_readlane_b32 s17, v12, 1
    v_readlane_b32 s18, v12, 2
    v_readlane_b32 s19, v12, 3
    v_readlane_b32 s20, v12, 4
    v_readlane_b32 s21, v12, 5
    v_readlane_b32 s22, v12, 6
    v_readlane_b32 s23, v12, 7
    v_readlane_b32 s24, v12, 8
    v_readlane_b32 s25, v12, 9
    v_readlane_b32 s26, v12, 10
    v_readlane_b32 s27, v12, 11
    v_readlane_b32 s48, v12, 12
    v_readlane_b32 s49, v12, 13
    v_readlane_b32 s50, v12, 14
    v_readlane_b32 s51, v12, 15
    v_readlane_b32 s52, v12, 16
    v_readlane_b32 s53, v12, 17
    v_readlane_b32 s54, v12, 18
    v_readlane_b32 s55, v12, 19
    v_readlane_b32 s36, v12, 20
    s_mov_b32 s72, 0xbdd2d3e8
    s_mov_b32 s73, s72
    s_mov_b32 s74, 0xbe9e1eee
    s_mov_b32 s75, s74
    s_mov_b32 s66, 1.0
    s_mov_b32 s67, 1.0
    v_mov_b32 v10, 0xc0135761
    v_mov_b32 v11, v10
    v_mov_b32 v64, 0
    v_mov_b32 v65, 0
    v_mov_b32 v66, 0
    v_mov_b32 v67, 0
    v_mov_b32 v68, 0
    v_mov_b32 v69, 0
    v_mov_b32 v70, 0
    v_mov_b32 v71, 0
    v_mov_b32 v72, 0
    v_mov_b32 v73, 0
    v_mov_b32 v74, 0
    v_mov_b32 v75, 0
    v_mov_b32 v76, 0
    v_mov_b32 v77, 0
    v_mov_b32 v78, 0
    v_mov_b32 v79, 0
    v_mov_b32 v80, 0
    v_mov_b32 v81, 0
    v_mov_b32 v82, 0
    v_mov_b32 v83, 0
    v_mov_b32 v84, 0
    v_mov_b32 v85, 0
    v_mov_b32 v86, 0
    v_mov_b32 v87, 0
    v_mov_b32 v88, 0
    v_mov_b32 v89, 0
    v_mov_b32 v90, 0
    v_mov_b32 v91, 0
    v_mov_b32 v92, 0
    v_mov_b32 v93, 0
    v_mov_b32 v94, 0
    v_mov_b32 v95, 0
    v_mov_b32 v96, 0
    v_mov_b32 v97, 0
    v_mov_b32 v98, 0
    v_mov_b32 v99, 0
    v_mov_b32 v100, 0
    v_mov_b32 v101, 0
    v_mov_b32 v102, 0
    v_mov_b32 v103, 0
    v_mov_b32 v104, 0
    v_mov_b32 v105, 0
    v_mov_b32 v106, 0
    v_mov_b32 v107, 0
    v_mov_b32 v108, 0
    v_mov_b32 v109, 0
    v_mov_b32 v110, 0
    v_mov_b32 v111, 0
    s_mov_b32 s68, 0
.p2align 3
L_mlp_loop:
    s_waitcnt vmcnt(0)
    v_lshlrev_b32 v2, 16, v56
    v_and_b32 v3, s62, v56
    v_lshlrev_b32 v4, 16, v58
    v_and_b32 v5, s62, v58
    v_lshlrev_b32 v6, 16, v60
    v_and_b32 v7, s62, v60
    v_pk_mul_f32 v[8:9], v[2:3], v[2:3]
    v_pk_mul_f32 v[16:17], v[4:5], v[4:5]
    v_pk_mul_f32 v[18:19], v[8:9], s[72:73]
    v_pk_mul_f32 v[8:9], v[8:9], s[74:75]
    v_pk_fma_f32 v[20:21], v[16:17], s[74:75], v[10:11]
    v_pk_fma_f32 v[16:17], v[16:17], s[72:73], v[10:11]
    v_pk_mul_f32 v[24:25], v[18:19], v[2:3]
    v_pk_mul_f32 v[26:27], v[8:9], v[4:5]
    v_pk_mul_f32 v[28:29], v[20:21], v[2:3]
    v_pk_mul_f32 v[30:31], v[16:17], v[4:5]
    v_pk_mul_f32 v[32:33], v[2:3], v[6:7]
    v_pk_mul_f32 v[34:35], v[4:5], v[6:7]
    v_lshlrev_b32 v2, 16, v57
    v_and_b32 v3, s62, v57
    v_lshlrev_b32 v4, 16, v59
    v_and_b32 v5, s62, v59
    v_lshlrev_b32 v6, 16, v61
    v_and_b32 v7, s62, v61
    v_add_u32 v1, 0x200, v1
    s_cmp_eq_u32 s68, 6
    s_cbranch_scc1 L_mlp_nold
    global_load_dwordx2 v[56:57], v1, s[28:29]
    global_load_dwordx2 v[58:59], v1, s[30:31]
    global_load_dwordx2 v[60:61], v1, s[32:33]
L_mlp_nold:
    v_pk_mul_f32 v[8:9], v[2:3], v[2:3]
    v_pk_mul_f32 v[16:17], v[4:5], v[4:5]
    v_pk_mul_f32 v[18:19], v[8:9], s[72:73]
    v_pk_mul_f32 v[8:9], v[8:9], s[74:75]
    v_pk_fma_f32 v[20:21], v[16:17], s[74:75], v[10:11]
    v_pk_fma_f32 v[16:17], v[16:17], s[72:73], v[10:11]
    v_pk_mul_f32 v[36:37], v[18:19], v[2:3]
    v_pk_mul_f32 v[38:39], v[8:9], v[4:5]
    v_pk_mul_f32 v[40:41], v[20:21], v[2:3]
    v_pk_mul_f32 v[42:43], v[16:17], v[4:5]
    v_pk_mul_f32 v[44:45], v[2:3], v[6:7]
    v_pk_mul_f32 v[46:47], v[4:5], v[6:7]
.p2align 3
    v_pk_fma_f32 v[2:3], v[24:25], s[16:17], v[26:27] op_sel:[0,0,0] op_sel_hi:[1,0,1]
    v_pk_fma_f32 v[4:5], v[36:37], s[16:17], v[38:39] op_sel:[0,0,0] op_sel_hi:[1,0,1]
    v_pk_fma_f32 v[2:3], v[2:3], s[16:17], v[28:29] op_sel:[0,0,0] op_sel_hi:[1,0,1]
    v_pk_fma_f32 v[4:5], v[4:5], s[16:17], v[40:41] op_sel:[0,0,0] op_sel_hi:[1,0,1]
    v_pk_fma_f32 v[2:3], v[2:3], s[16:17], v[30:31] op_sel:[0,0,0] op_sel_hi:[1,0,1]
    v_pk_fma_f32 v[4:5], v[4:5], s[16:17], v[42:43] op_sel:[0,0,0] op_sel_hi:[1,0,1]
    v_exp_f32 v2, v2
    v_exp_f32 v3, v3
    v_exp_f32 v4, v4
    v_exp_f32 v5, v5
    v_pk_fma_f32 v[6:7], v[32:33], s[16:17], v[34:35] op_sel:[0,0,0] op_sel_hi:[1,0,1]
    v_pk_fma_f32 v[8:9], v[44:45], s[16:17], v[46:47] op_sel:[0,0,0] op_sel_hi:[1,0,1]
    v_pk_add_f32 v[2:3], v[2:3], s[66:67]
    v_pk_add_f32 v[4:5], v[4:5], s[66:67]
    v_rcp_f32 v2, v2
    v_rcp_f32 v3, v3
    v_rcp_f32 v4, v4
    v_rcp_f32 v5, v5
    v_pk_fma_f32 v[64:65], v[6:7], v[2:3], v[64:65]
    v_pk_fma_f32 v[64:65], v[8:9], v[4:5], v[64:65]
    v_pk_fma_f32 v[48:49], v[24:25], s[16:17], v[26:27] op_sel:[0,1,0] op_sel_hi:[1,1,1]
    v_pk_fma_f32 v[50:51], v[36:37], s[16:17], v[38:39] op_sel:[0,1,0] op_sel_hi:[1,1,1]
    v_pk_fma_f32 v[48:49], v[48:49], s[16:17], v[28:29] op_sel:[0,1,0] op_sel_hi:[1,1,1]
    v_pk_fma_f32 v[50:51], v[50:51], s[16:17], v[40:41] op_sel:[0,1,0] op_sel_hi:[1,1,1]
    v_pk_fma_f32 v[48:49], v[48:49], s[16:17], v[30:31] op_sel:[0,1,0] op_sel_hi:[1,1,1]
    v_pk_fma_f32 v[50:51], v[50:51], s[16:17], v[42:43] op_sel:[0,1,0] op_sel_hi:[1,1,1]
    v_exp_f32 v48, v48
    v_exp_f32 v49, v49
    v_exp_f32 v50, v50
    v_exp_f32 v51, v51
    v_pk_fma_f32 v[52:53], v[32:33], s[16:17], v[34:35] op_sel:[0,1,0] op_sel_hi:[1,1,1]
    v_pk_fma_f32 v[54:55], v[44:45], s[16:17], v[46:47] op_sel:[0,1,0] op_sel_hi:[1,1,1]
    v_pk_add_f32 v[48:49], v[48:49], s[66:67]
    v_pk_add_f32 v[50:51], v[50:51], s[66:67]
    v_rcp_f32 v48, v48
    v_rcp_f32 v49, v49
    v_rcp_f32 v50, v50
    v_rcp_f32 v51, v51
    v_pk_fma_f32 v[66:67], v[52:53], v[48:49], v[66:67]
    v_pk_fma_f32 v[66:67], v[54:55], v[50:51], v[66:67]
    v_pk_fma_f32 v[2:3], v[24:25], s[18:19], v[26:27] op_sel:[0,0,0] op_sel_hi:[1,0,1]
    v_pk_fma_f32 v[4:5], v[36:37], s[18:19], v[38:39] op_sel:[0,0,0] op_sel_hi:[1,0,1]
    v_pk_fma_f32 v[2:3], v[2:3], s[18:19], v[28:29] op_sel:[0,0,0] op_sel_hi:[1,0,1]
    v_pk_fma_f32 v[4:5], v[4:5], s[18:19], v[40:41] op_sel:[0,0,0] op_sel_hi:[1,0,1]
    v_pk_fma_f32 v[2:3], v[2:3], s[18:19], v[30:31] op_sel:[0,0,0] op_sel_hi:[1,0,1]
    v_pk_fma_f32 v[4:5], v[4:5], s[18:19], v[42:43] op_sel:[0,0,0] op_sel_hi:[1,0,1]
    v_exp_f32 v2, v2
    v_exp_f32 v3, v3
    v_exp_f32 v4, v4
    v_exp_f32 v5, v5
    v_pk_fma_f32 v[6:7], v[32:33], s[18:19], v[34:35] op_sel:[0,0,0] op_sel_hi:[1,0,1]
    v_pk_fma_f32 v[8:9], v[44:45], s[18:19], v[46:47] op_sel:[0,0,0] op_sel_hi:[1,0,1]
    v_pk_add_f32 v[2:3], v[2:3], s[66:67]
    v_pk_add_f32 v[4:5], v[4:5], s[66:67]
    v_rcp_f32 v2, v2
    v_rcp_f32 v3, v3
    v_rcp_f32 v4, v4
    v_rcp_f32 v5, v5
    v_pk_fma_f32 v[68:69], v[6:7], v[2:3], v[68:69]
    v_pk_fma_f32 v[68:69], v[8:9], v[4:5], v[68:69]
    v_pk_fma_f32 v[48:49], v[24:25], s[18:19], v[26:27] op_sel:[0,1,0] op_sel_hi:[1,1,1]
    v_pk_fma_f32 v[50:51], v[36:37], s[18:19], v[38:39] op_sel:[0,1,0] op_sel_hi:[1,1,1]
    v_pk_fma_f32 v[48:49], v[48:49], s[18:19], v[28:29] op_sel:[0,1,0] op_sel_hi:[1,1,1]
    v_pk_fma_f32 v[50:51], v[50:51], s[18:19], v[40:41] op_sel:[0,1,0] op_sel_hi:[1,1,1]
    v_pk_fma_f32 v[48:49], v[48:49], s[18:19], v[30:31] op_sel:[0,1,0] op_sel_hi:[1,1,1]
    v_pk_fma_f32 v[50:51], v[50:51], s[18:19], v[42:43] op_sel:[0,1,0] op_sel_hi:[1,1,1]
    v_exp_f32 v48, v48
    v_exp_f32 v49, v49
    v_exp_f32 v50, v50
    v_exp_f32 v51, v51
    v_pk_fma_f32 v[52:53], v[32:33], s[18:19], v[34:35] op_sel:[0,1,0] op_sel_hi:[1,1,1]
    v_pk_fma_f32 v[54:55], v[44:45], s[18:19], v[46:47] op_sel:[0,1,0] op_sel_hi:[1,1,1]
    v_pk_add_f32 v[48:49], v[48:49], s[66:67]
    v_pk_add_f32 v[50:51], v[50:51], s[66:67]
    v_rcp_f32 v48, v48
    v_rcp_f32 v49, v49
    v_rcp_f32 v50, v50
    v_rcp_f32 v51, v51
    v_pk_fma_f32 v[70:71], v[52:53], v[48:49], v[70:71]
    v_pk_fma_f32 v[70:71], v[54:55], v[50:51], v[70:71]
    s_cmp_eq_u32 s65, 1
    s_cbranch_scc1 L_mlp_next
    v_pk_fma_f32 v[2:3], v[24:25], s[20:21], v[26:27] op_sel:[0,0,0] op_sel_hi:[1,0,1]
    v_pk_fma_f32 v[4:5], v[36:37], s[20:21], v[38:39] op_sel:[0,0,0] op_sel_hi:[1,0,1]
    v_pk_fma_f32 v[2:3], v[2:3], s[20:21], v[28:29] op_sel:[0,0,0] op_sel_hi:[1,0,1]
    v_pk_fma_f32 v[4:5], v[4:5], s[20:21], v[40:41] op_sel:[0,0,0] op_sel_hi:[1,0,1]
    v_pk_fma_f32 v[2:3], v[2:3], s[20:21], v[30:31] op_sel:[0,0,0] op_sel_hi:[1,0,1]
    v_pk_fma_f32 v[4:5], v[4:5], s[20:21], v[42:43] op_sel:[0,0,0] op_sel_hi:[1,0,1]
    v_exp_f32 v2, v2
    v_exp_f32 v3, v3
    v_exp_f32 v4, v4
    v_exp_f32 v5, v5
    v_pk_fma_f32 v[6:7], v[32:33], s[20:21], v[34:35] op_sel:[0,0,0] op_sel_hi:[1,0,1]
    v_pk_fma_f32 v[8:9], v[44:45], s[20:21], v[46:47] op_sel:[0,0,0] op_sel_hi:[1,0,1]
    v_pk_add_f32 v[2:3], v[2:3], s[66:67]
    v_pk_add_f32 v[4:5], v[4:5], s[66:67]
    v_rcp_f32 v2, v2
    v_rcp_f32 v3, v3
    v_rcp_f32 v4, v4
    v_rcp_f32 v5, v5
    v_pk_fma_f32 v[72:73], v[6:7], v[2:3], v[72:73]
    v_pk_fma_f32 v[72:73], v[8:9], v[4:5], v[72:73]
    v_pk_fma_f32 v[48:49], v[24:25], s[20:21], v[26:27] op_sel:[0,1,0] op_sel_hi:[1,1,1]
    v_pk_fma_f32 v[50:51], v[36:37], s[20:21], v[38:39] op_sel:[0,1,0] op_sel_hi:[1,1,1]
    v_pk_fma_f32 v[48:49], v[48:49], s[20:21], v[28:29] op_sel:[0,1,0] op_sel_hi:[1,1,1]
    v_pk_fma_f32 v[50:51], v[50:51], s[20:21], v[40:41] op_sel:[0,1,0] op_sel_hi:[1,1,1]
    v_pk_fma_f32 v[48:49], v[48:49], s[20:21], v[30:31] op_sel:[0,1,0] op_sel_hi:[1,1,1]
    v_pk_fma_f32 v[50:51], v[50:51], s[20:21], v[42:43] op_sel:[0,1,0] op_sel_hi:[1,1,1]
    v_exp_f32 v48, v48
    v_exp_f32 v49, v49
    v_exp_f32 v50, v50
    v_exp_f32 v51, v51
    v_pk_fma_f32 v[52:53], v[32:33], s[20:21], v[34:35] op_sel:[0,1,0] op_sel_hi:[1,1,1]
    v_pk_fma_f32 v[54:55], v[44:45], s[20:21], v[46:47] op_sel:[0,1,0] op_sel_hi:[1,1,1]
    v_pk_add_f32 v[48:49], v[48:49], s[66:67]
    v_pk_add_f32 v[50:51], v[50:51], s[66:67]
    v_rcp_f32 v48, v48
    v_rcp_f32 v49, v49
    v_rcp_f32 v50, v50
    v_rcp_f32 v51, v51
    v_pk_fma_f32 v[74:75], v[52:53], v[48:49], v[74:75]
    v_pk_fma_f32 v[74:75], v[54:55], v[50:51], v[74:75]
    v_pk_fma_f32 v[2:3], v[24:25], s[22:23], v[26:27] op_sel:[0,0,0] op_sel_hi:[1,0,1]
    v_pk_fma_f32 v[4:5], v[36:37], s[22:23], v[38:39] op_sel:[0,0,0] op_sel_hi:[1,0,1]
    v_pk_fma_f32 v[2:3], v[2:3], s[22:23], v[28:29] op_sel:[0,0,0] op_sel_hi:[1,0,1]
    v_pk_fma_f32 v[4:5], v[4:5], s[22:23], v[40:41] op_sel:[0,0,0] op_sel_hi:[1,0,1]
    v_pk_fma_f32 v[2:3], v[2:3], s[22:23], v[30:31] op_sel:[0,0,0] op_sel_hi:[1,0,1]
    v_pk_fma_f32 v[4:5], v[4:5], s[22:23], v[42:43] op_sel:[0,0,0] op_sel_hi:[1,0,1]
    v_exp_f32 v2, v2
    v_exp_f32 v3, v3
    v_exp_f32 v4, v4
    v_exp_f32 v5, v5
    v_pk_fma_f32 v[6:7], v[32:33], s[22:23], v[34:35] op_sel:[0,0,0] op_sel_hi:[1,0,1]
    v_pk_fma_f32 v[8:9], v[44:45], s[22:23], v[46:47] op_sel:[0,0,0] op_sel_hi:[1,0,1]
    v_pk_add_f32 v[2:3], v[2:3], s[66:67]
    v_pk_add_f32 v[4:5], v[4:5], s[66:67]
    v_rcp_f32 v2, v2
    v_rcp_f32 v3, v3
    v_rcp_f32 v4, v4
    v_rcp_f32 v5, v5
    v_pk_fma_f32 v[76:77], v[6:7], v[2:3], v[76:77]
    v_pk_fma_f32 v[76:77], v[8:9], v[4:5], v[76:77]
    v_pk_fma_f32 v[48:49], v[24:25], s[22:23], v[26:27] op_sel:[0,1,0] op_sel_hi:[1,1,1]
    v_pk_fma_f32 v[50:51], v[36:37], s[22:23], v[38:39] op_sel:[0,1,0] op_sel_hi:[1,1,1]
    v_pk_fma_f32 v[48:49], v[48:49], s[22:23], v[28:29] op_sel:[0,1,0] op_sel_hi:[1,1,1]
    v_pk_fma_f32 v[50:51], v[50:51], s[22:23], v[40:41] op_sel:[0,1,0] op_sel_hi:[1,1,1]
    v_pk_fma_f32 v[48:49], v[48:49], s[22:23], v[30:31] op_sel:[0,1,0] op_sel_hi:[1,1,1]
    v_pk_fma_f32 v[50:51], v[50:51], s[22:23], v[42:43] op_sel:[0,1,0] op_sel_hi:[1,1,1]
    v_exp_f32 v48, v48
    v_exp_f32 v49, v49
    v_exp_f32 v50, v50
    v_exp_f32 v51, v51
    v_pk_fma_f32 v[52:53], v[32:33], s[22:23], v[34:35] op_sel:[0,1,0] op_sel_hi:[1,1,1]
    v_pk_fma_f32 v[54:55], v[44:45], s[22:23], v[46:47] op_sel:[0,1,0] op_sel_hi:[1,1,1]
    v_pk_add_f32 v[48:49], v[48:49], s[66:67]
    v_pk_add_f32 v[50:51], v[50:51], s[66:67]
    v_rcp_f32 v48, v48
    v_rcp_f32 v49, v49
    v_rcp_f32 v50, v50
    v_rcp_f32 v51, v51
    v_pk_fma_f32 v[78:79], v[52:53], v[48:49], v[78:79]
    v_pk_fma_f32 v[78:79], v[54:55], v[50:51], v[78:79]
    v_pk_fma_f32 v[2:3], v[24:25], s[24:25], v[26:27] op_sel:[0,0,0] op_sel_hi:[1,0,1]
    v_pk_fma_f32 v[4:5], v[36:37], s[24:25], v[38:39] op_sel:[0,0,0] op_sel_hi:[1,0,1]
    v_pk_fma_f32 v[2:3], v[2:3], s[24:25], v[28:29] op_sel:[0,0,0] op_sel_hi:[1,0,1]
    v_pk_fma_f32 v[4:5], v[4:5], s[24:25], v[40:41] op_sel:[0,0,0] op_sel_hi:[1,0,1]
    v_pk_fma_f32 v[2:3], v[2:3], s[24:25], v[30:31] op_sel:[0,0,0] op_sel_hi:[1,0,1]
    v_pk_fma_f32 v[4:5], v[4:5], s[24:25], v[42:43] op_sel:[0,0,0] op_sel_hi:[1,0,1]
    v_exp_f32 v2, v2
    v_exp_f32 v3, v3
    v_exp_f32 v4, v4
    v_exp_f32 v5, v5
    v_pk_fma_f32 v[6:7], v[32:33], s[24:25], v[34:35] op_sel:[0,0,0] op_sel_hi:[1,0,1]
    v_pk_fma_f32 v[8:9], v[44:45], s[24:25], v[46:47] op_sel:[0,0,0] op_sel_hi:[1,0,1]
    v_pk_add_f32 v[2:3], v[2:3], s[66:67]
    v_pk_add_f32 v[4:5], v[4:5], s[66:67]
    v_rcp_f32 v2, v2
    v_rcp_f32 v3, v3
    v_rcp_f32 v4, v4
    v_rcp_f32 v5, v5
    v_pk_fma_f32 v[80:81], v[6:7], v[2:3], v[80:81]
    v_pk_fma_f32 v[80:81], v[8:9], v[4:5], v[80:81]
    v_pk_fma_f32 v[48:49], v[24:25], s[24:25], v[26:27] op_sel:[0,1,0] op_sel_hi:[1,1,1]
    v_pk_fma_f32 v[50:51], v[36:37], s[24:25], v[38:39] op_sel:[0,1,0] op_sel_hi:[1,1,1]
    v_pk_fma_f32 v[48:49], v[48:49], s[24:25], v[28:29] op_sel:[0,1,0] op_sel_hi:[1,1,1]
    v_pk_fma_f32 v[50:51], v[50:51], s[24:25], v[40:41] op_sel:[0,1,0] op_sel_hi:[1,1,1]
    v_pk_fma_f32 v[48:49], v[48:49], s[24:25], v[30:31] op_sel:[0,1,0] op_sel_hi:[1,1,1]
    v_pk_fma_f32 v[50:51], v[50:51], s[24:25], v[42:43] op_sel:[0,1,0] op_sel_hi:[1,1,1]
    v_exp_f32 v48, v48
    v_exp_f32 v49, v49
    v_exp_f32 v50, v50
    v_exp_f32 v51, v51
    v_pk_fma_f32 v[52:53], v[32:33], s[24:25], v[34:35] op_sel:[0,1,0] op_sel_hi:[1,1,1]
    v_pk_fma_f32 v[54:55], v[44:45], s[24:25], v[46:47] op_sel:[0,1,0] op_sel_hi:[1,1,1]
    v_pk_add_f32 v[48:49], v[48:49], s[66:67]
    v_pk_add_f32 v[50:51], v[50:51], s[66:67]
    v_rcp_f32 v48, v48
    v_rcp_f32 v49, v49
    v_rcp_f32 v50, v50
    v_rcp_f32 v51, v51
    v_pk_fma_f32 v[82:83], v[52:53], v[48:49], v[82:83]
    v_pk_fma_f32 v[82:83], v[54:55], v[50:51], v[82:83]
    v_pk_fma_f32 v[2:3], v[24:25], s[26:27], v[26:27] op_sel:[0,0,0] op_sel_hi:[1,0,1]
    v_pk_fma_f32 v[4:5], v[36:37], s[26:27], v[38:39] op_sel:[0,0,0] op_sel_hi:[1,0,1]
    v_pk_fma_f32 v[2:3], v[2:3], s[26:27], v[28:29] op_sel:[0,0,0] op_sel_hi:[1,0,1]
    v_pk_fma_f32 v[4:5], v[4:5], s[26:27], v[40:41] op_sel:[0,0,0] op_sel_hi:[1,0,1]
    v_pk_fma_f32 v[2:3], v[2:3], s[26:27], v[30:31] op_sel:[0,0,0] op_sel_hi:[1,0,1]
    v_pk_fma_f32 v[4:5], v[4:5], s[26:27], v[42:43] op_sel:[0,0,0] op_sel_hi:[1,0,1]
    v_exp_f32 v2, v2
    v_exp_f32 v3, v3
    v_exp_f32 v4, v4
    v_exp_f32 v5, v5
    v_pk_fma_f32 v[6:7], v[32:33], s[26:27], v[34:35] op_sel:[0,0,0] op_sel_hi:[1,0,1]
    v_pk_fma_f32 v[8:9], v[44:45], s[26:27], v[46:47] op_sel:[0,0,0] op_sel_hi:[1,0,1]
    v_pk_add_f32 v[2:3], v[2:3], s[66:67]
    v_pk_add_f32 v[4:5], v[4:5], s[66:67]
    v_rcp_f32 v2, v2
    v_rcp_f32 v3, v3
    v_rcp_f32 v4, v4
    v_rcp_f32 v5, v5
    v_pk_fma_f32 v[84:85], v[6:7], v[2:3], v[84:85]
    v_pk_fma_f32 v[84:85], v[8:9], v[4:5], v[84:85]
    v_pk_fma_f32 v[48:49], v[24:25], s[26:27], v[26:27] op_sel:[0,1,0] op_sel_hi:[1,1,1]
    v_pk_fma_f32 v[50:51], v[36:37], s[26:27], v[38:39] op_sel:[0,1,0] op_sel_hi:[1,1,1]
    v_pk_fma_f32 v[48:49], v[48:49], s[26:27], v[28:29] op_sel:[0,1,0] op_sel_hi:[1,1,1]
    v_pk_fma_f32 v[50:51], v[50:51], s[26:27], v[40:41] op_sel:[0,1,0] op_sel_hi:[1,1,1]
    v_pk_fma_f32 v[48:49], v[48:49], s[26:27], v[30:31] op_sel:[0,1,0] op_sel_hi:[1,1,1]
    v_pk_fma_f32 v[50:51], v[50:51], s[26:27], v[42:43] op_sel:[0,1,0] op_sel_hi:[1,1,1]
    v_exp_f32 v48, v48
    v_exp_f32 v49, v49
    v_exp_f32 v50, v50
    v_exp_f32 v51, v51
    v_pk_fma_f32 v[52:53], v[32:33], s[26:27], v[34:35] op_sel:[0,1,0] op_sel_hi:[1,1,1]
    v_pk_fma_f32 v[54:55], v[44:45], s[26:27], v[46:47] op_sel:[0,1,0] op_sel_hi:[1,1,1]
    v_pk_add_f32 v[48:49], v[48:49], s[66:67]
    v_pk_add_f32 v[50:51], v[50:51], s[66:67]
    v_rcp_f32 v48, v48
    v_rcp_f32 v49, v49
    v_rcp_f32 v50, v50
    v_rcp_f32 v51, v51
    v_pk_fma_f32 v[86:87], v[52:53], v[48:49], v[86:87]
    v_pk_fma_f32 v[86:87], v[54:55], v[50:51], v[86:87]
    v_pk_fma_f32 v[2:3], v[24:25], s[48:49], v[26:27] op_sel:[0,0,0] op_sel_hi:[1,0,1]
    v_pk_fma_f32 v[4:5], v[36:37], s[48:49], v[38:39] op_sel:[0,0,0] op_sel_hi:[1,0,1]
    v_pk_fma_f32 v[2:3], v[2:3], s[48:49], v[28:29] op_sel:[0,0,0] op_sel_hi:[1,0,1]
    v_pk_fma_f32 v[4:5], v[4:5], s[48:49], v[40:41] op_sel:[0,0,0] op_sel_hi:[1,0,1]
    v_pk_fma_f32 v[2:3], v[2:3], s[48:49], v[30:31] op_sel:[0,0,0] op_sel_hi:[1,0,1]
    v_pk_fma_f32 v[4:5], v[4:5], s[48:49], v[42:43] op_sel:[0,0,0] op_sel_hi:[1,0,1]
    v_exp_f32 v2, v2
    v_exp_f32 v3, v3
    v_exp_f32 v4, v4
    v_exp_f32 v5, v5
    v_pk_fma_f32 v[6:7], v[32:33], s[48:49], v[34:35] op_sel:[0,0,0] op_sel_hi:[1,0,1]
    v_pk_fma_f32 v[8:9], v[44:45], s[48:49], v[46:47] op_sel:[0,0,0] op_sel_hi:[1,0,1]
    v_pk_add_f32 v[2:3], v[2:3], s[66:67]
    v_pk_add_f32 v[4:5], v[4:5], s[66:67]
    v_rcp_f32 v2, v2
    v_rcp_f32 v3, v3
    v_rcp_f32 v4, v4
    v_rcp_f32 v5, v5
    v_pk_fma_f32 v[88:89], v[6:7], v[2:3], v[88:89]
    v_pk_fma_f32 v[88:89], v[8:9], v[4:5], v[88:89]
    v_pk_fma_f32 v[48:49], v[24:25], s[48:49], v[26:27] op_sel:[0,1,0] op_sel_hi:[1,1,1]
    v_pk_fma_f32 v[50:51], v[36:37], s[48:49], v[38:39] op_sel:[0,1,0] op_sel_hi:[1,1,1]
    v_pk_fma_f32 v[48:49], v[48:49], s[48:49], v[28:29] op_sel:[0,1,0] op_sel_hi:[1,1,1]
    v_pk_fma_f32 v[50:51], v[50:51], s[48:49], v[40:41] op_sel:[0,1,0] op_sel_hi:[1,1,1]
    v_pk_fma_f32 v[48:49], v[48:49], s[48:49], v[30:31] op_sel:[0,1,0] op_sel_hi:[1,1,1]
    v_pk_fma_f32 v[50:51], v[50:51], s[48:49], v[42:43] op_sel:[0,1,0] op_sel_hi:[1,1,1]
    v_exp_f32 v48, v48
    v_exp_f32 v49, v49
    v_exp_f32 v50, v50
    v_exp_f32 v51, v51
    v_pk_fma_f32 v[52:53], v[32:33], s[48:49], v[34:35] op_sel:[0,1,0] op_sel_hi:[1,1,1]
    v_pk_fma_f32 v[54:55], v[44:45], s[48:49], v[46:47] op_sel:[0,1,0] op_sel_hi:[1,1,1]
    v_pk_add_f32 v[48:49], v[48:49], s[66:67]
    v_pk_add_f32 v[50:51], v[50:51], s[66:67]
    v_rcp_f32 v48, v48
    v_rcp_f32 v49, v49
    v_rcp_f32 v50, v50
    v_rcp_f32 v51, v51
    v_pk_fma_f32 v[90:91], v[52:53], v[48:49], v[90:91]
    v_pk_fma_f32 v[90:91], v[54:55], v[50:51], v[90:91]
    v_pk_fma_f32 v[2:3], v[24:25], s[50:51], v[26:27] op_sel:[0,0,0] op_sel_hi:[1,0,1]
    v_pk_fma_f32 v[4:5], v[36:37], s[50:51], v[38:39] op_sel:[0,0,0] op_sel_hi:[1,0,1]
    v_pk_fma_f32 v[2:3], v[2:3], s[50:51], v[28:29] op_sel:[0,0,0] op_sel_hi:[1,0,1]
    v_pk_fma_f32 v[4:5], v[4:5], s[50:51], v[40:41] op_sel:[0,0,0] op_sel_hi:[1,0,1]
    v_pk_fma_f32 v[2:3], v[2:3], s[50:51], v[30:31] op_sel:[0,0,0] op_sel_hi:[1,0,1]
    v_pk_fma_f32 v[4:5], v[4:5], s[50:51], v[42:43] op_sel:[0,0,0] op_sel_hi:[1,0,1]
    v_exp_f32 v2, v2
    v_exp_f32 v3, v3
    v_exp_f32 v4, v4
    v_exp_f32 v5, v5
    v_pk_fma_f32 v[6:7], v[32:33], s[50:51], v[34:35] op_sel:[0,0,0] op_sel_hi:[1,0,1]
    v_pk_fma_f32 v[8:9], v[44:45], s[50:51], v[46:47] op_sel:[0,0,0] op_sel_hi:[1,0,1]
    v_pk_add_f32 v[2:3], v[2:3], s[66:67]
    v_pk_add_f32 v[4:5], v[4:5], s[66:67]
    v_rcp_f32 v2, v2
    v_rcp_f32 v3, v3
    v_rcp_f32 v4, v4
    v_rcp_f32 v5, v5
    v_pk_fma_f32 v[92:93], v[6:7], v[2:3], v[92:93]
    v_pk_fma_f32 v[92:93], v[8:9], v[4:5], v[92:93]
    v_pk_fma_f32 v[48:49], v[24:25], s[50:51], v[26:27] op_sel:[0,1,0] op_sel_hi:[1,1,1]
    v_pk_fma_f32 v[50:51], v[36:37], s[50:51], v[38:39] op_sel:[0,1,0] op_sel_hi:[1,1,1]
    v_pk_fma_f32 v[48:49], v[48:49], s[50:51], v[28:29] op_sel:[0,1,0] op_sel_hi:[1,1,1]
    v_pk_fma_f32 v[50:51], v[50:51], s[50:51], v[40:41] op_sel:[0,1,0] op_sel_hi:[1,1,1]
    v_pk_fma_f32 v[48:49], v[48:49], s[50:51], v[30:31] op_sel:[0,1,0] op_sel_hi:[1,1,1]
    v_pk_fma_f32 v[50:51], v[50:51], s[50:51], v[42:43] op_sel:[0,1,0] op_sel_hi:[1,1,1]
    v_exp_f32 v48, v48
    v_exp_f32 v49, v49
    v_exp_f32 v50, v50
    v_exp_f32 v51, v51
    v_pk_fma_f32 v[52:53], v[32:33], s[50:51], v[34:35] op_sel:[0,1,0] op_sel_hi:[1,1,1]
    v_pk_fma_f32 v[54:55], v[44:45], s[50:51], v[46:47] op_sel:[0,1,0] op_sel_hi:[1,1,1]
    v_pk_add_f32 v[48:49], v[48:49], s[66:67]
    v_pk_add_f32 v[50:51], v[50:51], s[66:67]
    v_rcp_f32 v48, v48
    v_rcp_f32 v49, v49
    v_rcp_f32 v50, v50
    v_rcp_f32 v51, v51
    v_pk_fma_f32 v[94:95], v[52:53], v[48:49], v[94:95]
    v_pk_fma_f32 v[94:95], v[54:55], v[50:51], v[94:95]
    v_pk_fma_f32 v[2:3], v[24:25], s[52:53], v[26:27] op_sel:[0,0,0] op_sel_hi:[1,0,1]
    v_pk_fma_f32 v[4:5], v[36:37], s[52:53], v[38:39] op_sel:[0,0,0] op_sel_hi:[1,0,1]
    v_pk_fma_f32 v[2:3], v[2:3], s[52:53], v[28:29] op_sel:[0,0,0] op_sel_hi:[1,0,1]
    v_pk_fma_f32 v[4:5], v[4:5], s[52:53], v[40:41] op_sel:[0,0,0] op_sel_hi:[1,0,1]
    v_pk_fma_f32 v[2:3], v[2:3], s[52:53], v[30:31] op_sel:[0,0,0] op_sel_hi:[1,0,1]
    v_pk_fma_f32 v[4:5], v[4:5], s[52:53], v[42:43] op_sel:[0,0,0] op_sel_hi:[1,0,1]
    v_exp_f32 v2, v2
    v_exp_f32 v3, v3
    v_exp_f32 v4, v4
    v_exp_f32 v5, v5
    v_pk_fma_f32 v[6:7], v[32:33], s[52:53], v[34:35] op_sel:[0,0,0] op_sel_hi:[1,0,1]
    v_pk_fma_f32 v[8:9], v[44:45], s[52:53], v[46:47] op_sel:[0,0,0] op_sel_hi:[1,0,1]
    v_pk_add_f32 v[2:3], v[2:3], s[66:67]
    v_pk_add_f32 v[4:5], v[4:5], s[66:67]
    v_rcp_f32 v2, v2
    v_rcp_f32 v3, v3
    v_rcp_f32 v4, v4
    v_rcp_f32 v5, v5
    v_pk_fma_f32 v[96:97], v[6:7], v[2:3], v[96:97]
    v_pk_fma_f32 v[96:97], v[8:9], v[4:5], v[96:97]
    v_pk_fma_f32 v[48:49], v[24:25], s[52:53], v[26:27] op_sel:[0,1,0] op_sel_hi:[1,1,1]
    v_pk_fma_f32 v[50:51], v[36:37], s[52:53], v[38:39] op_sel:[0,1,0] op_sel_hi:[1,1,1]
    v_pk_fma_f32 v[48:49], v[48:49], s[52:53], v[28:29] op_sel:[0,1,0] op_sel_hi:[1,1,1]
    v_pk_fma_f32 v[50:51], v[50:51], s[52:53], v[40:41] op_sel:[0,1,0] op_sel_hi:[1,1,1]
    v_pk_fma_f32 v[48:49], v[48:49], s[52:53], v[30:31] op_sel:[0,1,0] op_sel_hi:[1,1,1]
    v_pk_fma_f32 v[50:51], v[50:51], s[52:53], v[42:43] op_sel:[0,1,0] op_sel_hi:[1,1,1]
    v_exp_f32 v48, v48
    v_exp_f32 v49, v49
    v_exp_f32 v50, v50
    v_exp_f32 v51, v51
    v_pk_fma_f32 v[52:53], v[32:33], s[52:53], v[34:35] op_sel:[0,1,0] op_sel_hi:[1,1,1]
    v_pk_fma_f32 v[54:55], v[44:45], s[52:53], v[46:47] op_sel:[0,1,0] op_sel_hi:[1,1,1]
    v_pk_add_f32 v[48:49], v[48:49], s[66:67]
    v_pk_add_f32 v[50:51], v[50:51], s[66:67]
    v_rcp_f32 v48, v48
    v_rcp_f32 v49, v49
    v_rcp_f32 v50, v50
    v_rcp_f32 v51, v51
    v_pk_fma_f32 v[98:99], v[52:53], v[48:49], v[98:99]
    v_pk_fma_f32 v[98:99], v[54:55], v[50:51], v[98:99]
    v_pk_fma_f32 v[2:3], v[24:25], s[54:55], v[26:27] op_sel:[0,0,0] op_sel_hi:[1,0,1]
    v_pk_fma_f32 v[4:5], v[36:37], s[54:55], v[38:39] op_sel:[0,0,0] op_sel_hi:[1,0,1]
    v_pk_fma_f32 v[2:3], v[2:3], s[54:55], v[28:29] op_sel:[0,0,0] op_sel_hi:[1,0,1]
    v_pk_fma_f32 v[4:5], v[4:5], s[54:55], v[40:41] op_sel:[0,0,0] op_sel_hi:[1,0,1]
    v_pk_fma_f32 v[2:3], v[2:3], s[54:55], v[30:31] op_sel:[0,0,0] op_sel_hi:[1,0,1]
    v_pk_fma_f32 v[4:5], v[4:5], s[54:55], v[42:43] op_sel:[0,0,0] op_sel_hi:[1,0,1]
    v_exp_f32 v2, v2
    v_exp_f32 v3, v3
    v_exp_f32 v4, v4
    v_exp_f32 v5, v5
    v_pk_fma_f32 v[6:7], v[32:33], s[54:55], v[34:35] op_sel:[0,0,0] op_sel_hi:[1,0,1]
    v_pk_fma_f32 v[8:9], v[44:45], s[54:55], v[46:47] op_sel:[0,0,0] op_sel_hi:[1,0,1]
    v_pk_add_f32 v[2:3], v[2:3], s[66:67]
    v_pk_add_f32 v[4:5], v[4:5], s[66:67]
    v_rcp_f32 v2, v2
    v_rcp_f32 v3, v3
    v_rcp_f32 v4, v4
    v_rcp_f32 v5, v5
    v_pk_fma_f32 v[100:101], v[6:7], v[2:3], v[100:101]
    v_pk_fma_f32 v[100:101], v[8:9], v[4:5], v[100:101]
    v_pk_fma_f32 v[48:49], v[24:25], s[54:55], v[26:27] op_sel:[0,1,0] op_sel_hi:[1,1,1]
    v_pk_fma_f32 v[50:51], v[36:37], s[54:55], v[38:39] op_sel:[0,1,0] op_sel_hi:[1,1,1]
    v_pk_fma_f32 v[48:49], v[48:49], s[54:55], v[28:29] op_sel:[0,1,0] op_sel_hi:[1,1,1]
    v_pk_fma_f32 v[50:51], v[50:51], s[54:55], v[40:41] op_sel:[0,1,0] op_sel_hi:[1,1,1]
    v_pk_fma_f32 v[48:49], v[48:49], s[54:55], v[30:31] op_sel:[0,1,0] op_sel_hi:[1,1,1]
    v_pk_fma_f32 v[50:51], v[50:51], s[54:55], v[42:43] op_sel:[0,1,0] op_sel_hi:[1,1,1]
    v_exp_f32 v48, v48
    v_exp_f32 v49, v49
    v_exp_f32 v50, v50
    v_exp_f32 v51, v51
    v_pk_fma_f32 v[52:53], v[32:33], s[54:55], v[34:35] op_sel:[0,1,0] op_sel_hi:[1,1,1]
    v_pk_fma_f32 v[54:55], v[44:45], s[54:55], v[46:47] op_sel:[0,1,0] op_sel_hi:[1,1,1]
    v_pk_add_f32 v[48:49], v[48:49], s[66:67]
    v_pk_add_f32 v[50:51], v[50:51], s[66:67]
    v_rcp_f32 v48, v48
    v_rcp_f32 v49, v49
    v_rcp_f32 v50, v50
    v_rcp_f32 v51, v51
    v_pk_fma_f32 v[102:103], v[52:53], v[48:49], v[102:103]
    v_pk_fma_f32 v[102:103], v[54:55], v[50:51], v[102:103]
    v_pk_fma_f32 v[2:3], v[24:25], s[36:37], v[26:27] op_sel:[0,0,0] op_sel_hi:[1,0,1]
    v_pk_fma_f32 v[4:5], v[36:37], s[36:37], v[38:39] op_sel:[0,0,0] op_sel_hi:[1,0,1]
    v_pk_fma_f32 v[2:3], v[2:3], s[36:37], v[28:29] op_sel:[0,0,0] op_sel_hi:[1,0,1]
    v_pk_fma_f32 v[4:5], v[4:5], s[36:37], v[40:41] op_sel:[0,0,0] op_sel_hi:[1,0,1]
    v_pk_fma_f32 v[2:3], v[2:3], s[36:37], v[30:31] op_sel:[0,0,0] op_sel_hi:[1,0,1]
    v_pk_fma_f32 v[4:5], v[4:5], s[36:37], v[42:43] op_sel:[0,0,0] op_sel_hi:[1,0,1]
    v_exp_f32 v2, v2
    v_exp_f32 v3, v3
    v_exp_f32 v4, v4
    v_exp_f32 v5, v5
    v_pk_fma_f32 v[6:7], v[32:33], s[36:37], v[34:35] op_sel:[0,0,0] op_sel_hi:[1,0,1]
    v_pk_fma_f32 v[8:9], v[44:45], s[36:37], v[46:47] op_sel:[0,0,0] op_sel_hi:[1,0,1]
    v_pk_add_f32 v[2:3], v[2:3], s[66:67]
    v_pk_add_f32 v[4:5], v[4:5], s[66:67]
    v_rcp_f32 v2, v2
    v_rcp_f32 v3, v3
    v_rcp_f32 v4, v4
    v_rcp_f32 v5, v5
    v_pk_fma_f32 v[104:105], v[6:7], v[2:3], v[104:105]
    v_pk_fma_f32 v[104:105], v[8:9], v[4:5], v[104:105]
L_mlp_next:
    s_add_u32 s68, s68, 1
    s_cmp_lt_u32 s68, 7
    s_cbranch_scc1 L_mlp_loop
    v_add_f32 v64, v64, v65
    v_add_f32 v66, v66, v67
    v_add_f32 v68, v68, v69
    v_add_f32 v70, v70, v71
    v_add_f32 v72, v72, v73
    v_add_f32 v74, v74, v75
    v_add_f32 v76, v76, v77
    v_add_f32 v78, v78, v79
    v_add_f32 v80, v80, v81
    v_add_f32 v82, v82, v83
    v_add_f32 v84, v84, v85
    v_add_f32 v86, v86, v87
    v_add_f32 v88, v88, v89
    v_add_f32 v90, v90, v91
    v_add_f32 v92, v92, v93
    v_add_f32 v94, v94, v95
    v_add_f32 v96, v96, v97
    v_add_f32 v98, v98, v99
    v_add_f32 v100, v100, v101
    v_add_f32 v102, v102, v103
    v_add_f32 v104, v104, v105
    v_permlane32_swap_b32 v64, v66
    v_permlane32_swap_b32 v68, v70
    v_permlane32_swap_b32 v72, v74
    v_permlane32_swap_b32 v76, v78
    v_permlane32_swap_b32 v80, v82
    v_permlane32_swap_b32 v84, v86
    v_permlane32_swap_b32 v88, v90
    v_permlane32_swap_b32 v92, v94
    v_permlane32_swap_b32 v96, v98
    v_permlane32_swap_b32 v100, v102
    v_permlane32_swap_b32 v104, v106
    v_permlane32_swap_b32 v108, v110
    v_add_f32 v64, v64, v66
    v_add_f32 v68, v68, v70
    v_add_f32 v72, v72, v74
    v_add_f32 v76, v76, v78
    v_add_f32 v80, v80, v82
    v_add_f32 v84, v84, v86
    v_add_f32 v88, v88, v90
    v_add_f32 v92, v92, v94
    v_add_f32 v96, v96, v98
    v_add_f32 v100, v100, v102
    v_add_f32 v104, v104, v106
    v_add_f32 v108, v108, v110
    v_permlane16_swap_b32 v64, v68
    v_permlane16_swap_b32 v72, v76
    v_permlane16_swap_b32 v80, v84
    v_permlane16_swap_b32 v88, v92
    v_permlane16_swap_b32 v96, v100
    v_permlane16_swap_b32 v104, v108
    v_add_f32 v64, v64, v68
    v_add_f32 v72, v72, v76
    v_add_f32 v80, v80, v84
    v_add_f32 v88, v88, v92
    v_add_f32 v96, v96, v100
    v_add_f32 v104, v104, v108
    v_add_f32_dpp v64, v64, v64 row_ror:8 row_mask:0xf bank_mask:0xf
    v_add_f32_dpp v72, v72, v72 row_ror:8 row_mask:0xf bank_mask:0xf
    v_add_f32_dpp v80, v80, v80 row_ror:8 row_mask:0xf bank_mask:0xf
    v_add_f32_dpp v88, v88, v88 row_ror:8 row_mask:0xf bank_mask:0xf
    v_add_f32_dpp v96, v96, v96 row_ror:8 row_mask:0xf bank_mask:0xf
    v_add_f32_dpp v104, v104, v104 row_ror:8 row_mask:0xf bank_mask:0xf
    v_add_f32_dpp v64, v64, v64 row_ror:4 row_mask:0xf bank_mask:0xf
    v_add_f32_dpp v72, v72, v72 row_ror:4 row_mask:0xf bank_mask:0xf
    v_add_f32_dpp v80, v80, v80 row_ror:4 row_mask:0xf bank_mask:0xf
    v_add_f32_dpp v88, v88, v88 row_ror:4 row_mask:0xf bank_mask:0xf
    v_add_f32_dpp v96, v96, v96 row_ror:4 row_mask:0xf bank_mask:0xf
    v_add_f32_dpp v104, v104, v104 row_ror:4 row_mask:0xf bank_mask:0xf
    v_add_f32_dpp v64, v64, v64 row_ror:2 row_mask:0xf bank_mask:0xf
    v_add_f32_dpp v72, v72, v72 row_ror:2 row_mask:0xf bank_mask:0xf
    v_add_f32_dpp v80, v80, v80 row_ror:2 row_mask:0xf bank_mask:0xf
    v_add_f32_dpp v88, v88, v88 row_ror:2 row_mask:0xf bank_mask:0xf
    v_add_f32_dpp v96, v96, v96 row_ror:2 row_mask:0xf bank_mask:0xf
    v_add_f32_dpp v104, v104, v104 row_ror:2 row_mask:0xf bank_mask:0xf
    v_add_f32_dpp v64, v64, v64 row_ror:1 row_mask:0xf bank_mask:0xf
    v_add_f32_dpp v72, v72, v72 row_ror:1 row_mask:0xf bank_mask:0xf
    v_add_f32_dpp v80, v80, v80 row_ror:1 row_mask:0xf bank_mask:0xf
    v_add_f32_dpp v88, v88, v88 row_ror:1 row_mask:0xf bank_mask:0xf
    v_add_f32_dpp v96, v96, v96 row_ror:1 row_mask:0xf bank_mask:0xf
    v_add_f32_dpp v104, v104, v104 row_ror:1 row_mask:0xf bank_mask:0xf
    s_lshl_b32 s8, s3, 7
    s_add_u32 s8, s8, 131584
    v_lshrrev_b32 v2, 5, v0
    v_lshl_add_u32 v2, v2, 2, s8
    v_and_b32 v1, 16, v0
    v_lshrrev_b32 v1, 1, v1
    v_add_u32 v2, v2, v1
    v_and_b32 v1, 31, v0
    s_mov_b32 exec_lo, 0x00010001
    s_mov_b32 exec_hi, 0x00010001
    ds_write_b32 v2, v64 offset:0
    ds_write_b32 v2, v72 offset:16
    ds_write_b32 v2, v80 offset:32
    ds_write_b32 v2, v88 offset:48
    ds_write_b32 v2, v96 offset:64
    ds_write_b32 v2, v104 offset:80
    s_waitcnt lgkmcnt(0)
    s_lshl_b32 s8, s65, 2
    v_add_u32 v3, s8, v13
    s_mov_b64 exec, 1
    v_mov_b32 v6, 1
    ds_add_rtn_u32 v6, v3, v6 offset:16
    s_mov_b64 exec, -1
    s_waitcnt lgkmcnt(0)
    v_readfirstlane_b32 s8, v6
    s_bitcmp1_b32 s8, 0
    s_cbranch_scc1 L_mlp_last
    s_cmp_eq_u32 s65, 0
    s_cbranch_scc1 L_staged
    s_branch L_batchdone
L_mlp_last:
    v_lshlrev_b32 v2, 2, v1
    v_add_u32 v2, 131840, v2
    ds_read2_b32 v[16:17], v2 offset0:0 offset1:32
    s_lshl_b32 s47, s47, 16
    s_waitcnt lgkmcnt(0)
    v_add_f32 v16, v16, v17
    v_cvt_pk_bf16_f32 v16, 0, v16
    v_add_f32 v16, s47, v16
    v_cvt_pk_bf16_f32 v16, 0, v16
    s_cmp_eq_u32 s65, 1
    s_cbranch_scc1 L_output
    v_mov_b32_dpp v17, v16 quad_perm:[1,1,3,3] row_mask:0xf bank_mask:0xf
    v_cvt_pk_bf16_f32 v18, v16, v17
    v_lshlrev_b32 v2, 1, v0
    s_mul_i32 s8, s2, 40
    s_add_u32 s8, s8, 32768
    s_mov_b64 exec, 0x55555
    buffer_store_dword v18, v2, s[56:59], s8 offen sc1
    s_mov_b64 exec, 0x100000
    ds_write_b16 v13, v18 offset:23552
    s_mov_b64 exec, -1
    s_waitcnt vmcnt(0) lgkmcnt(0)
    s_mov_b64 exec, 1
    v_mov_b32 v6, 1
    ds_add_rtn_u32 v6, v13, v6 offset:24
    s_waitcnt lgkmcnt(0)
    v_readfirstlane_b32 s8, v6
    s_nop 0
    s_cmp_lg_u32 s8, 1
    s_cbranch_scc1 L_nodone_101
    s_lshl_b32 s8, s2, 2
    s_add_u32 s8, s8, 163840
    v_mov_b32 v6, s46
    buffer_store_dword v6, off, s[56:59], s8 sc1
L_nodone_101:
    s_mov_b64 exec, -1
L_staged:
    s_cmp_lg_u32 s3, 3
    s_cbranch_scc1 L_noctl
    s_mov_b32 s14, 0
L_spin_102:
    ds_read_b32 v6, v13 offset:36
    s_waitcnt lgkmcnt(0)
    v_readfirstlane_b32 s15, v6
    s_nop 0
    s_cmp_ge_u32 s15, 4
    s_cbranch_scc1 L_spun_103
    s_sleep 1
    s_add_u32 s14, s14, 1
    s_cmp_lt_u32 s14, 262144
    s_cbranch_scc1 L_spin_102
L_spun_103:
    s_bfe_u32 s10, s2, 0x30003
    s_mul_i32 s10, s10, 256
    s_add_u32 s10, s10, 196608
    s_mov_b32 s11, 1
    s_atomic_add s11, s[44:45], s10 glc
    s_waitcnt lgkmcnt(0)
    s_mov_b32 s8, -1
    s_cmp_ge_u32 s11, 8
    s_cselect_b32 s8, 0, s8
    s_cmp_ge_u32 s11, 20
    s_cselect_b32 s8, 1, s8
    s_cmp_ge_u32 s11, 28
    s_cselect_b32 s8, 2, s8
    v_mov_b32 v6, s8
    ds_write_b32 v13, v6 offset:40
    s_mov_b32 s14, 0
L_spin_104:
    ds_read_b32 v6, v13 offset:36
    s_waitcnt lgkmcnt(0)
    v_readfirstlane_b32 s15, v6
    s_nop 0
    s_cmp_ge_u32 s15, 8
    s_cbranch_scc1 L_spun_105
    s_sleep 1
    s_add_u32 s14, s14, 1
    s_cmp_lt_u32 s14, 262144
    s_cbranch_scc1 L_spin_104
L_spun_105:
    s_bfe_u32 s10, s2, 0x30003
    s_mul_i32 s10, s10, 256
    s_add_u32 s10, s10, 198656
    s_mov_b32 s11, 1
    s_atomic_add s11, s[44:45], s10 glc
    s_waitcnt lgkmcnt(0)
    s_mov_b32 s8, -1
    s_cmp_ge_u32 s11, 8
    s_cselect_b32 s8, 0, s8
    s_cmp_ge_u32 s11, 20
    s_cselect_b32 s8, 1, s8
    s_cmp_ge_u32 s11, 28
    s_cselect_b32 s8, 2, s8
    v_mov_b32 v6, s8
    ds_write_b32 v13, v6 offset:40
    s_mov_b32 s14, 0
L_spin_106:
    ds_read_b32 v6, v13 offset:36
    s_waitcnt lgkmcnt(0)
    v_readfirstlane_b32 s15, v6
    s_nop 0
    s_cmp_ge_u32 s15, 12
    s_cbranch_scc1 L_spun_107
    s_sleep 1
    s_add_u32 s14, s14, 1
    s_cmp_lt_u32 s14, 262144
    s_cbranch_scc1 L_spin_106
L_spun_107:
    s_bfe_u32 s10, s2, 0x30003
    s_mul_i32 s10, s10, 256
    s_add_u32 s10, s10, 200704
    s_mov_b32 s11, 1
    s_atomic_add s11, s[44:45], s10 glc
    s_waitcnt lgkmcnt(0)
    s_mov_b32 s8, -1
    s_cmp_ge_u32 s11, 8
    s_cselect_b32 s8, 0, s8
    s_cmp_ge_u32 s11, 20
    s_cselect_b32 s8, 1, s8
    s_cmp_ge_u32 s11, 28
    s_cselect_b32 s8, 2, s8
    v_mov_b32 v6, s8
    ds_write_b32 v13, v6 offset:40
    s_mov_b32 s14, 0
L_spin_108:
    ds_read_b32 v6, v13 offset:36
    s_waitcnt lgkmcnt(0)
    v_readfirstlane_b32 s15, v6
    s_nop 0
    s_cmp_ge_u32 s15, 16
    s_cbranch_scc1 L_spun_109
    s_sleep 1
    s_add_u32 s14, s14, 1
    s_cmp_lt_u32 s14, 262144
    s_cbranch_scc1 L_spin_108
L_spun_109:
    s_bfe_u32 s10, s2, 0x30003
    s_mul_i32 s10, s10, 256
    s_add_u32 s10, s10, 202752
    s_mov_b32 s11, 1
    s_atomic_add s11, s[44:45], s10 glc
    s_waitcnt lgkmcnt(0)
    s_mov_b32 s8, -1
    s_cmp_ge_u32 s11, 8
    s_cselect_b32 s8, 0, s8
    s_cmp_ge_u32 s11, 20
    s_cselect_b32 s8, 1, s8
    s_cmp_ge_u32 s11, 28
    s_cselect_b32 s8, 2, s8
    v_mov_b32 v6, s8
    ds_write_b32 v13, v6 offset:40
    s_mov_b32 s14, 0
L_spin_110:
    ds_read_b32 v6, v13 offset:36
    s_waitcnt lgkmcnt(0)
    v_readfirstlane_b32 s15, v6
    s_nop 0
    s_cmp_ge_u32 s15, 20
    s_cbranch_scc1 L_spun_111
    s_sleep 1
    s_add_u32 s14, s14, 1
    s_cmp_lt_u32 s14, 262144
    s_cbranch_scc1 L_spin_110
L_spun_111:
    s_bfe_u32 s10, s2, 0x30003
    s_mul_i32 s10, s10, 256
    s_add_u32 s10, s10, 204800
    s_mov_b32 s11, 1
    s_atomic_add s11, s[44:45], s10 glc
    s_waitcnt lgkmcnt(0)
    s_mov_b32 s8, -1
    s_cmp_ge_u32 s11, 5
    s_cselect_b32 s8, 0, s8
    s_cmp_ge_u32 s11, 21
    s_cselect_b32 s8, 1, s8
    s_cmp_ge_u32 s11, 29
    s_cselect_b32 s8, 2, s8
    v_mov_b32 v6, s8
    ds_write_b32 v13, v6 offset:40
    s_mov_b32 s14, 0
L_spin_112:
    ds_read_b32 v6, v13 offset:36
    s_waitcnt lgkmcnt(0)
    v_readfirstlane_b32 s15, v6
    s_nop 0
    s_cmp_ge_u32 s15, 24
    s_cbranch_scc1 L_spun_113
    s_sleep 1
    s_add_u32 s14, s14, 1
    s_cmp_lt_u32 s14, 262144
    s_cbranch_scc1 L_spin_112
L_spun_113:
    s_bfe_u32 s10, s2, 0x30003
    s_mul_i32 s10, s10, 256
    s_add_u32 s10, s10, 206848
    s_mov_b32 s11, 1
    s_atomic_add s11, s[44:45], s10 glc
    s_waitcnt lgkmcnt(0)
    s_mov_b32 s8, -1
    s_cmp_ge_u32 s11, 3
    s_cselect_b32 s8, 0, s8
    s_cmp_ge_u32 s11, 21
    s_cselect_b32 s8, 1, s8
    s_cmp_ge_u32 s11, 29
    s_cselect_b32 s8, 2, s8
    v_mov_b32 v6, s8
    ds_write_b32 v13, v6 offset:40
    s_mov_b32 s14, 0
L_spin_114:
    ds_read_b32 v6, v13 offset:36
    s_waitcnt lgkmcnt(0)
    v_readfirstlane_b32 s15, v6
    s_nop 0
    s_cmp_ge_u32 s15, 28
    s_cbranch_scc1 L_spun_115
    s_sleep 1
    s_add_u32 s14, s14, 1
    s_cmp_lt_u32 s14, 262144
    s_cbranch_scc1 L_spin_114
L_spun_115:
    s_bfe_u32 s10, s2, 0x30003
    s_mul_i32 s10, s10, 256
    s_add_u32 s10, s10, 208896
    s_mov_b32 s11, 1
    s_atomic_add s11, s[44:45], s10 glc
    s_waitcnt lgkmcnt(0)
    s_mov_b32 s8, -1
    s_cmp_ge_u32 s11, 0
    s_cselect_b32 s8, 0, s8
    s_cmp_ge_u32 s11, 20
    s_cselect_b32 s8, 1, s8
    s_cmp_ge_u32 s11, 28
    s_cselect_b32 s8, 2, s8
    v_mov_b32 v6, s8
    ds_write_b32 v13, v6 offset:40
L_noctl:
    s_setprio 0
    s_add_u32 s3, s3, 4
    s_waitcnt lgkmcnt(0)
    s_and_b32 s8, s2, 0xc7
    s_cmp_lg_u32 s8, 0
    s_cbranch_scc1 L_fin
    s_barrier
    v_lshrrev_b32 v4, 4, v0
    v_and_b32 v5, 15, v0
    v_lshrrev_b32 v9, 5, v0
    s_movk_i32 s76, 0x1111
    s_mov_b32 s77, s76
    v_lshl_add_u32 v229, v0, 4, v13
    v_lshlrev_b32 v230, 2, v5
    v_lshl_add_u32 v230, v9, 6, v230
    s_lshl_b32 s72, s6, 11
    s_lshl_b32 s8, s7, 7
    s_add_u32 s72, s72, s8
    s_add_u32 s72, s72, 786432
    v_and_b32 v7, 1, v5
    v_lshlrev_b32 v7, 4, v7
    v_mov_b32 v8, 0x3f80
    v_lshlrev_b32 v7, v7, v8
    v_and_b32 v8, 14, v5
    v_cmp_eq_u32 vcc, 0, v8
    s_nop 1
    v_cndmask_b32 v232, 0, v7, vcc
    v_cmp_eq_u32 vcc, 4, v8
    s_nop 1
    v_cndmask_b32 v233, 0, v7, vcc
    v_cmp_eq_u32 vcc, 8, v8
    s_nop 1
    v_cndmask_b32 v234, 0, v7, vcc
    v_cmp_eq_u32 vcc, 12, v8
    s_nop 1
    v_cndmask_b32 v235, 0, v7, vcc
    v_lshlrev_b32 v244, 13, v4
    v_lshl_add_u32 v244, v5, 4, v244
    v_lshrrev_b32 v6, 3, v5
    v_lshlrev_b32 v6, 6, v6
    v_and_b32 v8, 1, v4
    v_lshl_add_u32 v6, v8, 5, v6
    v_and_b32 v8, 4, v5
    v_lshl_add_u32 v6, v8, 2, v6
    v_and_b32 v8, 3, v5
    v_lshl_add_u32 v6, v8, 1, v6
    v_lshrrev_b32 v8, 1, v4
    s_lshl_b32 s8, s3, 7
    v_add3_u32 v6, v6, v8, s8
    v_lshlrev_b32 v238, 1, v6
    v_mad_u32_u24 v228, v9, 14, v238
    s_and_b32 s8, s2, 0xc7
    s_cmp_lg_u32 s8, 0
    s_cbranch_scc1 L_noprep_116
    v_mov_b32 v231, 0x02020202
    v_mul_lo_u32 v231, v231, v9
    v_add_u32 v231, s60, v231
    v_add_u32 v7, v13, v238
    ds_read_u16 v248, v7 offset:3072
    ds_read_u16 v249, v7 offset:3088
    ds_read_u16 v250, v7 offset:5120
    ds_read_u16 v251, v7 offset:5136
    ds_read_u16 v252, v7 offset:7168
    ds_read_u16 v253, v7 offset:7184
    ds_read_u16 v254, v7 offset:9216
    ds_read_u16 v255, v7 offset:9232
    ds_read_u16 v236, v7 offset:11264
    ds_read_u16 v237, v7 offset:11280
    s_lshl_b32 s75, s3, 8
    s_add_u32 s75, s75, 786432
    s_add_u32 s73, s75, 4096
    s_mov_b32 s66, 0x3a800000
    s_mov_b32 s67, s66
    v_lshlrev_b32 v246, 2, v9
    s_lshl_b32 s8, s3, 3
    v_add3_u32 v246, s8, v246, v13
    v_mov_b32 v245, 5120
    v_mov_b32 v247, 154624
    s_mov_b32 s68, 116224
    s_mov_b32 s69, 0x3727c5ac
    s_mov_b32 s78, 0x10000
    s_mov_b32 s79, s78
    s_mov_b32 s70, 0x11111111
    s_mov_b32 s71, s70
    s_waitcnt lgkmcnt(0)
    v_lshlrev_b32 v248, 16, v248
    v_lshlrev_b32 v249, 16, v249
    v_lshlrev_b32 v250, 16, v250
    v_lshlrev_b32 v251, 16, v251
    v_lshlrev_b32 v252, 16, v252
    v_lshlrev_b32 v253, 16, v253
    v_lshlrev_b32 v254, 16, v254
    v_lshlrev_b32 v255, 16, v255
    v_lshlrev_b32 v236, 16, v236
    v_lshlrev_b32 v237, 16, v237
    v_add_f32 v254, 1.0, v254
    v_add_f32 v255, 1.0, v255
    v_cvt_pk_bf16_f32 v254, 0, v254
    v_cvt_pk_bf16_f32 v255, 0, v255
    s_lshl_b32 s8, s3, 5
    s_add_u32 s8, s8, 159232
    v_lshl_add_u32 v246, v4, 3, s8
    v_and_b32 v8, 7, v0
    v_lshlrev_b32 v8, 5, v8
    v_lshl_add_u32 v239, v4, 3, v8
    v_add_u32 v239, 159232, v239
    s_mov_b32 s78, 0x10001
    s_mov_b32 s79, s78
    v_add_f32 v44, v254, v255
    v_mul_f32 v45, v254, v254
    v_fmac_f32 v45, v255, v255
    v_add_f32 v46, v252, v253
    v_mul_f32 v47, v252, v252
    v_fmac_f32 v47, v253, v253
    v_mul_f32 v48, v254, v252
    v_fmac_f32 v48, v255, v253
    v_mov_b32 v49, 0
    v_permlane32_swap_b32 v44, v45
    v_permlane32_swap_b32 v46, v47
    v_permlane32_swap_b32 v48, v49
    v_add_f32 v44, v44, v45
    v_add_f32 v46, v46, v47
    v_add_f32 v48, v48, v49
    s_nop 0
    v_permlane16_swap_b32 v44, v46
    v_add_f32 v44, v44, v46
    v_add_f32_dpp v48, v48, v48 row_ror:8 row_mask:0xf bank_mask:0xf
    s_nop 0
    v_add_f32_dpp v44, v44, v44 row_ror:8 row_mask:0xf bank_mask:0xf
    v_add_f32_dpp v48, v48, v48 row_ror:4 row_mask:0xf bank_mask:0xf
    s_nop 0
    v_add_f32_dpp v44, v44, v44 row_ror:4 row_mask:0xf bank_mask:0xf
    v_add_f32_dpp v48, v48, v48 row_ror:2 row_mask:0xf bank_mask:0xf
    s_nop 0
    v_add_f32_dpp v44, v44, v44 row_ror:2 row_mask:0xf bank_mask:0xf
    v_add_f32_dpp v48, v48, v48 row_ror:1 row_mask:0xf bank_mask:0xf
    s_nop 0
    v_add_f32_dpp v44, v44, v44 row_ror:1 row_mask:0xf bank_mask:0xf
    s_mov_b64 exec, s[78:79]
    ds_write2_b32 v246, v44, v48 offset0:64 offset1:65
    s_mov_b64 exec, -1
    s_waitcnt lgkmcnt(0)
L_noprep_116:
    s_branch L_tail
L_attn2:
    v_lshlrev_b32 v5, 4, v0
    s_mov_b32 s54, s50
    s_mov_b32 s55, 0x20000
    s_mov_b32 s60, 0x05040100
    s_mov_b32 s61, 0x07060302
    s_mov_b32 s63, 0x3db504f3
    s_mov_b32 s64, 0x3fb8aa3b
    s_mov_b32 s58, 0x400000
    s_mov_b32 s59, 0x20000
    v_and_b32 v6, 3, v14
    v_lshlrev_b32 v6, 2, v6
    v_lshrrev_b32 v15, 2, v14
    v_add_u32 v6, v6, v15
    v_lshlrev_b32 v6, 8, v6
    v_xor_b32 v15, v13, v14
    v_lshl_add_u32 v6, v15, 4, v6
    v_add_u32 v6, s12, v6
    v_xor_b32 v7, 64, v6
    v_xor_b32 v8, 0x80, v6
    v_xor_b32 v9, 0xc0, v6
    v_mov_b32 v13, 131072
    v_mov_b32 v14, 0
    v_lshl_add_u32 v15, v0, 2, v13
    ds_write_b32 v15, v14
    s_mov_b32 s70, 0xff00ff00
    s_mov_b32 s71, 0xff00ff00
    s_mov_b64 s[52:53], s[20:21]
    s_mov_b64 s[56:57], s[44:45]
    s_mov_b64 s[66:67], s[24:25]
    s_waitcnt lgkmcnt(0)
    s_barrier
    s_mov_b32 s14, 0
L_spin_1:
    ds_read_b32 v14, v13 offset:32
    s_waitcnt lgkmcnt(0)
    v_readfirstlane_b32 s15, v14
    s_nop 0
    s_cmp_ge_u32 s15, 1
    s_cbranch_scc1 L_spun_2
    s_sleep 1
    s_add_u32 s14, s14, 1
    s_cmp_lt_u32 s14, 262144
    s_cbranch_scc1 L_spin_1
L_spun_2:
    buffer_load_dwordx4 v3, s[48:51], s10 offen offset:2048 nt lds
    buffer_load_dwordx4 v4, s[48:51], s10 offen offset:3072 nt lds
    s_add_u32 m0, s12, 4096
    s_add_u32 s10, s9, 4096
    buffer_load_dwordx4 v1, s[48:51], s10 offen offset:0 nt lds
    buffer_load_dwordx4 v2, s[48:51], s10 offen offset:1024 nt lds
    s_waitcnt vmcnt(5)
    buffer_load_dwordx4 v3, s[48:51], s10 offen offset:2048 nt lds
    s_waitcnt vmcnt(5)
    buffer_load_dwordx4 v4, s[48:51], s10 offen offset:3072 nt lds
    s_add_u32 m0, s12, 8192
    s_add_u32 s10, s9, 2097152
    s_waitcnt vmcnt(5)
    buffer_load_dwordx4 v1, s[48:51], s10 offen offset:0 nt lds
    s_waitcnt vmcnt(5)
    buffer_load_dwordx4 v2, s[48:51], s10 offen offset:1024 nt lds
    s_waitcnt vmcnt(5)
    buffer_load_dwordx4 v3, s[48:51], s10 offen offset:2048 nt lds
    s_waitcnt vmcnt(5)
    buffer_load_dwordx4 v4, s[48:51], s10 offen offset:3072 nt lds
    s_add_u32 m0, s12, 12288
    s_add_u32 s10, s9, 2101248
    s_waitcnt vmcnt(5)
    buffer_load_dwordx4 v1, s[48:51], s10 offen offset:0 nt lds
    s_waitcnt vmcnt(5)
    buffer_load_dwordx4 v2, s[48:51], s10 offen offset:1024 nt lds
    s_waitcnt lgkmcnt(0)
    s_mov_b64 exec, 1
    v_mov_b32 v14, 1
    ds_add_u32 v13, v14 offset:12
    s_mov_b64 exec, -1
    s_waitcnt vmcnt(5)
    buffer_load_dwordx4 v3, s[48:51], s10 offen offset:2048 nt lds
    s_waitcnt vmcnt(5)
    buffer_load_dwordx4 v4, s[48:51], s10 offen offset:3072 nt lds
    s_add_u32 m0, s12, 16384
    s_add_u32 s10, s9, 4194304
    s_waitcnt vmcnt(5)
    buffer_load_dwordx4 v1, s[48:51], s10 offen offset:0 nt lds
    s_waitcnt vmcnt(5)
    buffer_load_dwordx4 v2, s[48:51], s10 offen offset:1024 nt lds
    s_waitcnt vmcnt(5)
    buffer_load_dwordx4 v3, s[48:51], s10 offen offset:2048 nt lds
    s_waitcnt vmcnt(5)
    buffer_load_dwordx4 v4, s[48:51], s10 offen offset:3072 nt lds
    s_add_u32 m0, s12, 20480
    s_add_u32 s10, s9, 4198400
    s_waitcnt vmcnt(5)
    buffer_load_dwordx4 v1, s[48:51], s10 offen offset:0 nt lds
    s_waitcnt vmcnt(5)
    buffer_load_dwordx4 v2, s[48:51], s10 offen offset:1024 nt lds
    s_waitcnt vmcnt(5)
    buffer_load_dwordx4 v3, s[48:51], s10 offen offset:2048 nt lds
    s_waitcnt vmcnt(5)
    buffer_load_dwordx4 v4, s[48:51], s10 offen offset:3072 nt lds
    s_add_u32 m0, s12, 24576
    s_add_u32 s10, s9, 6291456
    s_waitcnt vmcnt(5)
    buffer_load_dwordx4 v1, s[48:51], s10 offen offset:0 nt lds
    s_waitcnt vmcnt(5)
    buffer_load_dwordx4 v2, s[48:51], s10 offen offset:1024 nt lds
    s_waitcnt vmcnt(5)
    buffer_load_dwordx4 v3, s[48:51], s10 offen offset:2048 nt lds
    s_waitcnt vmcnt(5)
    buffer_load_dwordx4 v4, s[48:51], s10 offen offset:3072 nt lds
    s_add_u32 m0, s12, 28672
    s_add_u32 s10, s9, 6295552
    s_waitcnt vmcnt(5)
    buffer_load_dwordx4 v1, s[48:51], s10 offen offset:0 nt lds
    s_waitcnt vmcnt(5)
    buffer_load_dwordx4 v2, s[48:51], s10 offen offset:1024 nt lds
    s_waitcnt vmcnt(5)
    buffer_load_dwordx4 v3, s[48:51], s10 offen offset:2048 nt lds
    s_waitcnt vmcnt(5)
    buffer_load_dwordx4 v4, s[48:51], s10 offen offset:3072 nt lds
    s_lshl_b32 s8, s3, 12
    s_add_u32 m0, s8, 134144
    s_add_u32 s10, s9, 8388608
    s_waitcnt vmcnt(5)
    buffer_load_dwordx4 v1, s[48:51], s10 offen offset:0 nt lds
    s_waitcnt vmcnt(5)
    buffer_load_dwordx4 v2, s[48:51], s10 offen offset:1024 nt lds
    s_waitcnt vmcnt(5)
    buffer_load_dwordx4 v3, s[48:51], s10 offen offset:2048 nt lds
    s_waitcnt vmcnt(5)
    buffer_load_dwordx4 v4, s[48:51], s10 offen offset:3072 nt lds
    s_add_u32 s10, s9, 8392704
    s_waitcnt vmcnt(5)
    buffer_load_dwordx4 v[144:147], v1, s[48:51], s10 offen offset:0 nt
    s_waitcnt vmcnt(5)
    buffer_load_dwordx4 v[148:151], v2, s[48:51], s10 offen offset:1024 nt
    s_waitcnt vmcnt(5)
    buffer_load_dwordx4 v[152:155], v3, s[48:51], s10 offen offset:2048 nt
    s_waitcnt vmcnt(5)
    buffer_load_dwordx4 v[156:159], v4, s[48:51], s10 offen offset:3072 nt
    s_add_u32 s10, s9, 10485760
    s_waitcnt vmcnt(5)
    buffer_load_dwordx4 v[160:163], v1, s[48:51], s10 offen offset:0 nt
    s_waitcnt vmcnt(5)
    buffer_load_dwordx4 v[164:167], v2, s[48:51], s10 offen offset:1024 nt
    s_waitcnt vmcnt(5)
    buffer_load_dwordx4 v[168:171], v3, s[48:51], s10 offen offset:2048 nt
    s_waitcnt vmcnt(5)
    buffer_load_dwordx4 v[172:175], v4, s[48:51], s10 offen offset:3072 nt
    s_add_u32 s10, s9, 10489856
    s_waitcnt vmcnt(5)
    buffer_load_dwordx4 v[176:179], v1, s[48:51], s10 offen offset:0 nt
    s_waitcnt vmcnt(5)
    buffer_load_dwordx4 v[180:183], v2, s[48:51], s10 offen offset:1024 nt
    s_waitcnt vmcnt(5)
    buffer_load_dwordx4 v[184:187], v3, s[48:51], s10 offen offset:2048 nt
    s_waitcnt vmcnt(5)
    buffer_load_dwordx4 v[188:191], v4, s[48:51], s10 offen offset:3072 nt
    s_add_u32 s10, s9, 12582912
    s_waitcnt vmcnt(5)
    buffer_load_dwordx4 v[192:195], v1, s[48:51], s10 offen offset:0 nt
    s_waitcnt vmcnt(5)
    buffer_load_dwordx4 v[196:199], v2, s[48:51], s10 offen offset:1024 nt
    s_waitcnt vmcnt(5)
    buffer_load_dwordx4 v[200:203], v3, s[48:51], s10 offen offset:2048 nt
    s_waitcnt vmcnt(5)
    buffer_load_dwordx4 v[204:207], v4, s[48:51], s10 offen offset:3072 nt
    s_add_u32 s10, s9, 12587008
    s_waitcnt vmcnt(5)
    buffer_load_dwordx4 v[208:211], v1, s[48:51], s10 offen offset:0 nt
    s_waitcnt lgkmcnt(0)
    s_mov_b64 exec, 1
    v_mov_b32 v14, 1
    ds_add_u32 v13, v14 offset:12
    s_mov_b64 exec, -1
    s_waitcnt vmcnt(5)
    buffer_load_dwordx4 v[212:215], v2, s[48:51], s10 offen offset:1024 nt
    s_waitcnt vmcnt(5)
    buffer_load_dwordx4 v[216:219], v3, s[48:51], s10 offen offset:2048 nt
    s_waitcnt vmcnt(5)
    buffer_load_dwordx4 v[220:223], v4, s[48:51], s10 offen offset:3072 nt
    s_add_u32 s10, s9, 14680064
    s_waitcnt vmcnt(5)
    buffer_load_dwordx4 v[224:227], v1, s[48:51], s10 offen offset:0 nt
    s_waitcnt vmcnt(5)
    buffer_load_dwordx4 v[228:231], v2, s[48:51], s10 offen offset:1024 nt
    s_waitcnt vmcnt(5)
    buffer_load_dwordx4 v[232:235], v3, s[48:51], s10 offen offset:2048 nt
    s_waitcnt vmcnt(5)
    buffer_load_dwordx4 v[236:239], v4, s[48:51], s10 offen offset:3072 nt
    s_add_u32 s10, s9, 14684160
    s_waitcnt vmcnt(5)
    buffer_load_dwordx4 v[240:243], v1, s[48:51], s10 offen offset:0 nt
    s_waitcnt vmcnt(5)
    buffer_load_dwordx4 v[244:247], v2, s[48:51], s10 offen offset:1024 nt
    s_waitcnt vmcnt(5)
    buffer_load_dwordx4 v[248:251], v3, s[48:51], s10 offen offset:2048 nt
    s_waitcnt vmcnt(5)
    buffer_load_dwordx4 v[252:255], v4, s[48:51], s10 offen offset:3072 nt
    s_mov_b64 vcc, 0
    s_mov_b32 s13, 1
    s_add_u32 s10, s9, 0
    s_waitcnt vmcnt(7)
    s_cbranch_vccnz L_go_3
    s_waitcnt vmcnt(5)
    s_cmp_eq_u32 s13, 2
    s_cbranch_scc1 L_go_3
    s_waitcnt vmcnt(4)
    s_cmp_eq_u32 s13, 1
    s_cbranch_scc1 L_go_3
    s_waitcnt vmcnt(3)
L_go_3:
    buffer_load_dwordx4 v[128:131], v5, s[52:55], s10 offen offset:0 nt
    s_mov_b32 s14, 0
L_spin_4:
    ds_read_b32 v14, v13 offset:4
    s_waitcnt lgkmcnt(0)
    v_readfirstlane_b32 s15, v14
    s_nop 0
    s_cmp_ge_u32 s15, 1
    s_cbranch_scc1 L_spun_5
    s_sleep 1
    s_add_u32 s14, s14, 1
    s_cmp_lt_u32 s14, 262144
    s_cbranch_scc1 L_spin_4
L_spun_5:
    v_and_b32 v14, 7, v0
    v_lshlrev_b32 v14, 8, v14
    v_lshrrev_b32 v15, 4, v0
    v_lshl_add_u32 v14, v15, 4, v14
    v_add_u32 v14, 132096, v14
    ds_read_b128 v[16:19], v14 offset:0
    ds_read_b128 v[20:23], v14 offset:64
    ds_read_b128 v[24:27], v14 offset:128
    ds_read_b128 v[28:31], v14 offset:192
    v_add_u32 v1, s12, v5
    s_waitcnt vmcnt(7)
    s_cbranch_vccnz L_go_6
    s_waitcnt vmcnt(5)
    s_cmp_eq_u32 s13, 2
    s_cbranch_scc1 L_go_6
    s_waitcnt vmcnt(4)
    s_cmp_eq_u32 s13, 1
    s_cbranch_scc1 L_go_6
    s_waitcnt vmcnt(3)
L_go_6:
    buffer_load_dwordx4 v[132:135], v5, s[52:55], s10 offen offset:1024 nt
    s_waitcnt lgkmcnt(0)
    s_mov_b64 exec, 1
    v_mov_b32 v14, 1
    ds_add_u32 v13, v14 offset:36
    s_mov_b64 exec, -1
    s_waitcnt lgkmcnt(0)
    s_mov_b64 exec, 1
    v_mov_b32 v14, 1
    ds_add_u32 v13, v14 offset:12
    s_mov_b64 exec, -1
    ds_read_b128 v[96:99], v6 offset:0
    ds_read_b128 v[100:103], v7 offset:0
    ds_read_b128 v[104:107], v8 offset:0
    ds_read_b128 v[108:111], v9 offset:0
    ds_read_b128 v[112:115], v6 offset:4096
    ds_read_b128 v[116:119], v7 offset:4096
    ds_read_b128 v[120:123], v8 offset:4096
    ds_read_b128 v[124:127], v9 offset:4096
    s_waitcnt lgkmcnt(7)
    v_mfma_f32_16x16x32_bf16 v[32:35], v[96:99], v[16:19], 0
    s_waitcnt lgkmcnt(6)
    v_mfma_f32_16x16x32_bf16 v[32:35], v[100:103], v[20:23], v[32:35]
    s_waitcnt lgkmcnt(5)
    v_mfma_f32_16x16x32_bf16 v[32:35], v[104:107], v[24:27], v[32:35]
    s_waitcnt lgkmcnt(4)
    v_mfma_f32_16x16x32_bf16 v[32:35], v[108:111], v[28:31], v[32:35]
    s_waitcnt lgkmcnt(3)
    v_mfma_f32_16x16x32_bf16 v[36:39], v[112:115], v[16:19], 0
    s_waitcnt lgkmcnt(2)
    v_mfma_f32_16x16x32_bf16 v[36:39], v[116:119], v[20:23], v[36:39]
    s_waitcnt lgkmcnt(1)
    v_mfma_f32_16x16x32_bf16 v[36:39], v[120:123], v[24:27], v[36:39]
    s_waitcnt lgkmcnt(0)
    v_mfma_f32_16x16x32_bf16 v[36:39], v[124:127], v[28:31], v[36:39]
    s_waitcnt vmcnt(7)
    s_cbranch_vccnz L_go_7
    s_waitcnt vmcnt(5)
    s_cmp_eq_u32 s13, 2
    s_cbranch_scc1 L_go_7
    s_waitcnt vmcnt(4)
    s_cmp_eq_u32 s13, 1
    s_cbranch_scc1 L_go_7
    s_waitcnt vmcnt(3)
L_go_7:
    buffer_load_dwordx4 v[136:139], v5, s[52:55], s10 offen offset:2048 nt
    ds_write_b128 v1, v[144:147] offset:4096
    ds_write_b128 v1, v[148:151] offset:5120
    ds_write_b128 v1, v[152:155] offset:6144
    ds_write_b128 v1, v[156:159] offset:7168
    s_waitcnt vmcnt(7)
    s_cbranch_vccnz L_go_8
    s_waitcnt vmcnt(5)
    s_cmp_eq_u32 s13, 2
    s_cbranch_scc1 L_go_8
    s_waitcnt vmcnt(4)
    s_cmp_eq_u32 s13, 1
    s_cbranch_scc1 L_go_8
    s_waitcnt vmcnt(3)
L_go_8:
    buffer_load_dwordx4 v[140:143], v5, s[52:55], s10 offen offset:3072 nt
    ds_read_b128 v[96:99], v6 offset:8192
    ds_read_b128 v[100:103], v7 offset:8192
    ds_read_b128 v[104:107], v8 offset:8192
    ds_read_b128 v[108:111], v9 offset:8192
    ds_read_b128 v[112:115], v6 offset:12288
    ds_read_b128 v[116:119], v7 offset:12288
    ds_read_b128 v[120:123], v8 offset:12288
    ds_read_b128 v[124:127], v9 offset:12288
    s_waitcnt lgkmcnt(7)
    v_mfma_f32_16x16x32_bf16 v[40:43], v[96:99], v[16:19], 0
    s_waitcnt lgkmcnt(6)
    v_mfma_f32_16x16x32_bf16 v[40:43], v[100:103], v[20:23], v[40:43]
    s_waitcnt lgkmcnt(5)
    v_mfma_f32_16x16x32_bf16 v[40:43], v[104:107], v[24:27], v[40:43]
    s_waitcnt lgkmcnt(4)
    v_mfma_f32_16x16x32_bf16 v[40:43], v[108:111], v[28:31], v[40:43]
    s_waitcnt lgkmcnt(3)
    v_mfma_f32_16x16x32_bf16 v[44:47], v[112:115], v[16:19], 0
    s_waitcnt lgkmcnt(2)
    v_mfma_f32_16x16x32_bf16 v[44:47], v[116:119], v[20:23], v[44:47]
    s_waitcnt lgkmcnt(1)
    v_mfma_f32_16x16x32_bf16 v[44:47], v[120:123], v[24:27], v[44:47]
    s_waitcnt lgkmcnt(0)
    v_mfma_f32_16x16x32_bf16 v[44:47], v[124:127], v[28:31], v[44:47]
    s_add_u32 s10, s9, 4096
    s_waitcnt vmcnt(7)
    s_cbranch_vccnz L_go_9
    s_waitcnt vmcnt(5)
    s_cmp_eq_u32 s13, 2
    s_cbranch_scc1 L_go_9
    s_waitcnt vmcnt(4)
    s_cmp_eq_u32 s13, 1
    s_cbranch_scc1 L_go_9
    s_waitcnt vmcnt(3)
L_go_9:
    buffer_load_dwordx4 v[144:147], v5, s[52:55], s10 offen offset:0 nt
    ds_read_b32 v14, v13 offset:40
    s_waitcnt lgkmcnt(0)
    v_readfirstlane_b32 s13, v14
    s_nop 0
    s_add_u32 s13, s13, 1
    s_cmp_eq_u32 s13, 3
    s_cselect_b64 vcc, -1, 0
    ds_write_b128 v1, v[160:163] offset:8192
    ds_write_b128 v1, v[164:167] offset:9216
    ds_write_b128 v1, v[168:171] offset:10240
    ds_write_b128 v1, v[172:175] offset:11264
    v_cvt_pk_bf16_f32 v32, 0, v32
    v_cvt_pk_bf16_f32 v33, 0, v33
    v_cvt_pk_bf16_f32 v34, 0, v34
    v_cvt_pk_bf16_f32 v35, 0, v35
    v_cvt_pk_bf16_f32 v36, 0, v36
    v_cvt_pk_bf16_f32 v37, 0, v37
    v_cvt_pk_bf16_f32 v38, 0, v38
    v_cvt_pk_bf16_f32 v39, 0, v39
    v_mul_f32 v32, s63, v32
    v_mul_f32 v33, s63, v33
    v_mul_f32 v34, s63, v34
    v_mul_f32 v35, s63, v35
    v_mul_f32 v36, s63, v36
    v_mul_f32 v37, s63, v37
    v_mul_f32 v38, s63, v38
    v_mul_f32 v39, s63, v39
    v_cvt_pk_bf16_f32 v32, 0, v32
    v_cvt_pk_bf16_f32 v33, 0, v33
    v_cvt_pk_bf16_f32 v34, 0, v34
    v_cvt_pk_bf16_f32 v35, 0, v35
    v_cvt_pk_bf16_f32 v36, 0, v36
    v_cvt_pk_bf16_f32 v37, 0, v37
    v_cvt_pk_bf16_f32 v38, 0, v38
    v_cvt_pk_bf16_f32 v39, 0, v39
    v_max_f32 v15, v32, v33
    v_max3_f32 v15, v34, v35, v15
    v_max3_f32 v15, v36, v37, v15
    v_max3_f32 v15, v38, v39, v15
    s_waitcnt vmcnt(7)
    s_cbranch_vccnz L_go_10
    s_waitcnt vmcnt(5)
    s_cmp_eq_u32 s13, 2
    s_cbranch_scc1 L_go_10
    s_waitcnt vmcnt(4)
    s_cmp_eq_u32 s13, 1
    s_cbranch_scc1 L_go_10
    s_waitcnt vmcnt(3)
L_go_10:
    buffer_load_dwordx4 v[148:151], v5, s[52:55], s10 offen offset:1024 nt
    ds_write_b128 v1, v[176:179] offset:12288
    ds_write_b128 v1, v[180:183] offset:13312
    ds_write_b128 v1, v[184:187] offset:14336
    ds_write_b128 v1, v[188:191] offset:15360
    s_waitcnt vmcnt(7)
    s_cbranch_vccnz L_go_11
    s_waitcnt vmcnt(5)
    s_cmp_eq_u32 s13, 2
    s_cbranch_scc1 L_go_11
    s_waitcnt vmcnt(4)
    s_cmp_eq_u32 s13, 1
    s_cbranch_scc1 L_go_11
    s_waitcnt vmcnt(3)
L_go_11:
    buffer_load_dwordx4 v[152:155], v5, s[52:55], s10 offen offset:2048 nt
    ds_read_b32 v14, v13 offset:40
    s_waitcnt lgkmcnt(0)
    v_readfirstlane_b32 s13, v14
    s_nop 0
    s_add_u32 s13, s13, 1
    s_cmp_eq_u32 s13, 3
    s_cselect_b64 vcc, -1, 0
    ds_read_b128 v[96:99], v6 offset:16384
    ds_read_b128 v[100:103], v7 offset:16384
    ds_read_b128 v[104:107], v8 offset:16384
    ds_read_b128 v[108:111], v9 offset:16384
    ds_read_b128 v[112:115], v6 offset:20480
    ds_read_b128 v[116:119], v7 offset:20480
    ds_read_b128 v[120:123], v8 offset:20480
    ds_read_b128 v[124:127], v9 offset:20480
    s_waitcnt lgkmcnt(7)
    v_mfma_f32_16x16x32_bf16 v[48:51], v[96:99], v[16:19], 0
    s_waitcnt lgkmcnt(6)
    v_mfma_f32_16x16x32_bf16 v[48:51], v[100:103], v[20:23], v[48:51]
    s_waitcnt lgkmcnt(5)
    v_mfma_f32_16x16x32_bf16 v[48:51], v[104:107], v[24:27], v[48:51]
    s_waitcnt lgkmcnt(4)
    v_mfma_f32_16x16x32_bf16 v[48:51], v[108:111], v[28:31], v[48:51]
    s_waitcnt lgkmcnt(3)
    v_mfma_f32_16x16x32_bf16 v[52:55], v[112:115], v[16:19], 0
    s_waitcnt lgkmcnt(2)
    v_mfma_f32_16x16x32_bf16 v[52:55], v[116:119], v[20:23], v[52:55]
    s_waitcnt lgkmcnt(1)
    v_mfma_f32_16x16x32_bf16 v[52:55], v[120:123], v[24:27], v[52:55]
    s_waitcnt lgkmcnt(0)
    v_mfma_f32_16x16x32_bf16 v[52:55], v[124:127], v[28:31], v[52:55]
    s_waitcnt vmcnt(7)
    s_cbranch_vccnz L_go_12
    s_waitcnt vmcnt(5)
    s_cmp_eq_u32 s13, 2
    s_cbranch_scc1 L_go_12
    s_waitcnt vmcnt(4)
    s_cmp_eq_u32 s13, 1
    s_cbranch_scc1 L_go_12
    s_waitcnt vmcnt(3)
L_go_12:
    buffer_load_dwordx4 v[156:159], v5, s[52:55], s10 offen offset:3072 nt
    ds_write_b128 v1, v[192:195] offset:16384
    ds_write_b128 v1, v[196:199] offset:17408
    ds_write_b128 v1, v[200:203] offset:18432
    ds_write_b128 v1, v[204:207] offset:19456
    v_cvt_pk_bf16_f32 v40, 0, v40
    v_cvt_pk_bf16_f32 v41, 0, v41
    v_cvt_pk_bf16_f32 v42, 0, v42
    v_cvt_pk_bf16_f32 v43, 0, v43
    v_cvt_pk_bf16_f32 v44, 0, v44
    v_cvt_pk_bf16_f32 v45, 0, v45
    v_cvt_pk_bf16_f32 v46, 0, v46
    v_cvt_pk_bf16_f32 v47, 0, v47
    v_mul_f32 v40, s63, v40
    v_mul_f32 v41, s63, v41
    v_mul_f32 v42, s63, v42
    v_mul_f32 v43, s63, v43
    v_mul_f32 v44, s63, v44
    v_mul_f32 v45, s63, v45
    v_mul_f32 v46, s63, v46
    v_mul_f32 v47, s63, v47
    v_cvt_pk_bf16_f32 v40, 0, v40
    v_cvt_pk_bf16_f32 v41, 0, v41
    v_cvt_pk_bf16_f32 v42, 0, v42
    v_cvt_pk_bf16_f32 v43, 0, v43
    v_cvt_pk_bf16_f32 v44, 0, v44
    v_cvt_pk_bf16_f32 v45, 0, v45
    v_cvt_pk_bf16_f32 v46, 0, v46
    v_cvt_pk_bf16_f32 v47, 0, v47
    v_max3_f32 v15, v40, v41, v15
    v_max3_f32 v15, v42, v43, v15
    v_max3_f32 v15, v44, v45, v15
    v_max3_f32 v15, v46, v47, v15
    s_add_u32 s10, s9, 2097152
    s_waitcnt vmcnt(7)
    s_cbranch_vccnz L_go_13
    s_waitcnt vmcnt(5)
    s_cmp_eq_u32 s13, 2
    s_cbranch_scc1 L_go_13
    s_waitcnt vmcnt(4)
    s_cmp_eq_u32 s13, 1
    s_cbranch_scc1 L_go_13
    s_waitcnt vmcnt(3)
L_go_13:
    buffer_load_dwordx4 v[160:163], v5, s[52:55], s10 offen offset:0 nt
    ds_read_b32 v14, v13 offset:40
    s_waitcnt lgkmcnt(0)
    v_readfirstlane_b32 s13, v14
    s_nop 0
    s_add_u32 s13, s13, 1
    s_cmp_eq_u32 s13, 3
    s_cselect_b64 vcc, -1, 0
    ds_write_b128 v1, v[208:211] offset:20480
    ds_write_b128 v1, v[212:215] offset:21504
    ds_write_b128 v1, v[216:219] offset:22528
    ds_write_b128 v1, v[220:223] offset:23552
    s_waitcnt vmcnt(7)
    s_cbranch_vccnz L_go_14
    s_waitcnt vmcnt(5)
    s_cmp_eq_u32 s13, 2
    s_cbranch_scc1 L_go_14
    s_waitcnt vmcnt(4)
    s_cmp_eq_u32 s13, 1
    s_cbranch_scc1 L_go_14
    s_waitcnt vmcnt(3)
L_go_14:
    buffer_load_dwordx4 v[164:167], v5, s[52:55], s10 offen offset:1024 nt
    s_waitcnt lgkmcnt(0)
    s_mov_b64 exec, 1
    v_mov_b32 v14, 1
    ds_add_u32 v13, v14 offset:36
    s_mov_b64 exec, -1
    ds_read_b128 v[96:99], v6 offset:24576
    ds_read_b128 v[100:103], v7 offset:24576
    ds_read_b128 v[104:107], v8 offset:24576
    ds_read_b128 v[108:111], v9 offset:24576
    ds_read_b128 v[112:115], v6 offset:28672
    ds_read_b128 v[116:119], v7 offset:28672
    ds_read_b128 v[120:123], v8 offset:28672
    ds_read_b128 v[124:127], v9 offset:28672
    s_waitcnt lgkmcnt(7)
    v_mfma_f32_16x16x32_bf16 v[56:59], v[96:99], v[16:19], 0
    s_waitcnt lgkmcnt(6)
    v_mfma_f32_16x16x32_bf16 v[56:59], v[100:103], v[20:23], v[56:59]
    s_waitcnt lgkmcnt(5)
    v_mfma_f32_16x16x32_bf16 v[56:59], v[104:107], v[24:27], v[56:59]
    s_waitcnt lgkmcnt(4)
    v_mfma_f32_16x16x32_bf16 v[56:59], v[108:111], v[28:31], v[56:59]
    s_waitcnt lgkmcnt(3)
    v_mfma_f32_16x16x32_bf16 v[60:63], v[112:115], v[16:19], 0
    s_waitcnt lgkmcnt(2)
    v_mfma_f32_16x16x32_bf16 v[60:63], v[116:119], v[20:23], v[60:63]
    s_waitcnt lgkmcnt(1)
    v_mfma_f32_16x16x32_bf16 v[60:63], v[120:123], v[24:27], v[60:63]
    s_waitcnt lgkmcnt(0)
    v_mfma_f32_16x16x32_bf16 v[60:63], v[124:127], v[28:31], v[60:63]
    s_waitcnt vmcnt(7)
    s_cbranch_vccnz L_go_15
    s_waitcnt vmcnt(5)
    s_cmp_eq_u32 s13, 2
    s_cbranch_scc1 L_go_15
    s_waitcnt vmcnt(4)
    s_cmp_eq_u32 s13, 1
    s_cbranch_scc1 L_go_15
    s_waitcnt vmcnt(3)
L_go_15:
    buffer_load_dwordx4 v[168:171], v5, s[52:55], s10 offen offset:2048 nt
    ds_write_b128 v1, v[224:227] offset:24576
    ds_write_b128 v1, v[228:231] offset:25600
    ds_write_b128 v1, v[232:235] offset:26624
    ds_write_b128 v1, v[236:239] offset:27648
    v_cvt_pk_bf16_f32 v48, 0, v48
    v_cvt_pk_bf16_f32 v49, 0, v49
    v_cvt_pk_bf16_f32 v50, 0, v50
    v_cvt_pk_bf16_f32 v51, 0, v51
    v_cvt_pk_bf16_f32 v52, 0, v52
    v_cvt_pk_bf16_f32 v53, 0, v53
    v_cvt_pk_bf16_f32 v54, 0, v54
    v_cvt_pk_bf16_f32 v55, 0, v55
    v_mul_f32 v48, s63, v48
    v_mul_f32 v49, s63, v49
    v_mul_f32 v50, s63, v50
    v_mul_f32 v51, s63, v51
    v_mul_f32 v52, s63, v52
    v_mul_f32 v53, s63, v53
    v_mul_f32 v54, s63, v54
    v_mul_f32 v55, s63, v55
    v_cvt_pk_bf16_f32 v48, 0, v48
    v_cvt_pk_bf16_f32 v49, 0, v49
    v_cvt_pk_bf16_f32 v50, 0, v50
    v_cvt_pk_bf16_f32 v51, 0, v51
    v_cvt_pk_bf16_f32 v52, 0, v52
    v_cvt_pk_bf16_f32 v53, 0, v53
    v_cvt_pk_bf16_f32 v54, 0, v54
    v_cvt_pk_bf16_f32 v55, 0, v55
    v_max3_f32 v15, v48, v49, v15
    v_max3_f32 v15, v50, v51, v15
    v_max3_f32 v15, v52, v53, v15
    v_max3_f32 v15, v54, v55, v15
    s_waitcnt vmcnt(7)
    s_cbranch_vccnz L_go_16
    s_waitcnt vmcnt(5)
    s_cmp_eq_u32 s13, 2
    s_cbranch_scc1 L_go_16
    s_waitcnt vmcnt(4)
    s_cmp_eq_u32 s13, 1
    s_cbranch_scc1 L_go_16
    s_waitcnt vmcnt(3)
L_go_16:
    buffer_load_dwordx4 v[172:175], v5, s[52:55], s10 offen offset:3072 nt
    ds_write_b128 v1, v[240:243] offset:28672
    ds_write_b128 v1, v[244:247] offset:29696
    ds_write_b128 v1, v[248:251] offset:30720
    ds_write_b128 v1, v[252:255] offset:31744
    v_cvt_pk_bf16_f32 v56, 0, v56
    v_cvt_pk_bf16_f32 v57, 0, v57
    v_cvt_pk_bf16_f32 v58, 0, v58
    v_cvt_pk_bf16_f32 v59, 0, v59
    v_cvt_pk_bf16_f32 v60, 0, v60
    v_cvt_pk_bf16_f32 v61, 0, v61
    v_cvt_pk_bf16_f32 v62, 0, v62
    v_cvt_pk_bf16_f32 v63, 0, v63
    v_mul_f32 v56, s63, v56
    v_mul_f32 v57, s63, v57
    v_mul_f32 v58, s63, v58
    v_mul_f32 v59, s63, v59
    v_mul_f32 v60, s63, v60
    v_mul_f32 v61, s63, v61
    v_mul_f32 v62, s63, v62
    v_mul_f32 v63, s63, v63
    v_cvt_pk_bf16_f32 v56, 0, v56
    v_cvt_pk_bf16_f32 v57, 0, v57
    v_cvt_pk_bf16_f32 v58, 0, v58
    v_cvt_pk_bf16_f32 v59, 0, v59
    v_cvt_pk_bf16_f32 v60, 0, v60
    v_cvt_pk_bf16_f32 v61, 0, v61
    v_cvt_pk_bf16_f32 v62, 0, v62
    v_cvt_pk_bf16_f32 v63, 0, v63
    v_max3_f32 v15, v56, v57, v15
    v_max3_f32 v15, v58, v59, v15
    v_max3_f32 v15, v60, v61, v15
    v_max3_f32 v15, v62, v63, v15
    s_add_u32 s10, s9, 2101248
    s_waitcnt vmcnt(7)
    s_cbranch_vccnz L_go_17
    s_waitcnt vmcnt(5)
    s_cmp_eq_u32 s13, 2
    s_cbranch_scc1 L_go_17
    s_waitcnt vmcnt(4)
    s_cmp_eq_u32 s13, 1
    s_cbranch_scc1 L_go_17
    s_waitcnt vmcnt(3)
L_go_17:
    buffer_load_dwordx4 v[176:179], v5, s[52:55], s10 offen offset:0 nt
    ds_read_b32 v14, v13 offset:40
    s_waitcnt lgkmcnt(0)
    v_readfirstlane_b32 s13, v14
    s_nop 0
    s_add_u32 s13, s13, 1
    s_cmp_eq_u32 s13, 3
    s_cselect_b64 vcc, -1, 0
    s_mul_i32 s8, s3, 0x7000
    s_sub_u32 s8, 134144, s8
    v_add_u32 v96, s8, v6
    ds_read_b128 v[96:99], v96
    v_add_u32 v100, s8, v7
    ds_read_b128 v[100:103], v100
    v_add_u32 v104, s8, v8
    ds_read_b128 v[104:107], v104
    v_add_u32 v108, s8, v9
    ds_read_b128 v[108:111], v108
    ds_read_b128 v[112:115], v6 offset:4096
    ds_read_b128 v[116:119], v7 offset:4096
    ds_read_b128 v[120:123], v8 offset:4096
    ds_read_b128 v[124:127], v9 offset:4096
    s_waitcnt lgkmcnt(7)
    v_mfma_f32_16x16x32_bf16 v[64:67], v[96:99], v[16:19], 0
    s_waitcnt lgkmcnt(6)
    v_mfma_f32_16x16x32_bf16 v[64:67], v[100:103], v[20:23], v[64:67]
    s_waitcnt lgkmcnt(5)
    v_mfma_f32_16x16x32_bf16 v[64:67], v[104:107], v[24:27], v[64:67]
    s_waitcnt lgkmcnt(4)
    v_mfma_f32_16x16x32_bf16 v[64:67], v[108:111], v[28:31], v[64:67]
    s_waitcnt lgkmcnt(3)
    v_mfma_f32_16x16x32_bf16 v[68:71], v[112:115], v[16:19], 0
    s_waitcnt lgkmcnt(2)
    v_mfma_f32_16x16x32_bf16 v[68:71], v[116:119], v[20:23], v[68:71]
    s_waitcnt lgkmcnt(1)
    v_mfma_f32_16x16x32_bf16 v[68:71], v[120:123], v[24:27], v[68:71]
    s_waitcnt lgkmcnt(0)
    v_mfma_f32_16x16x32_bf16 v[68:71], v[124:127], v[28:31], v[68:71]
    s_waitcnt vmcnt(7)
    s_cbranch_vccnz L_go_18
    s_waitcnt vmcnt(5)
    s_cmp_eq_u32 s13, 2
    s_cbranch_scc1 L_go_18
    s_waitcnt vmcnt(4)
    s_cmp_eq_u32 s13, 1
    s_cbranch_scc1 L_go_18
    s_waitcnt vmcnt(3)
L_go_18:
    buffer_load_dwordx4 v[180:183], v5, s[52:55], s10 offen offset:1024 nt
    ds_read_b128 v[96:99], v6 offset:8192
    ds_read_b128 v[100:103], v7 offset:8192
    ds_read_b128 v[104:107], v8 offset:8192
    ds_read_b128 v[108:111], v9 offset:8192
    ds_read_b128 v[112:115], v6 offset:12288
    ds_read_b128 v[116:119], v7 offset:12288
    ds_read_b128 v[120:123], v8 offset:12288
    ds_read_b128 v[124:127], v9 offset:12288
    s_waitcnt lgkmcnt(7)
    v_mfma_f32_16x16x32_bf16 v[72:75], v[96:99], v[16:19], 0
    s_waitcnt lgkmcnt(6)
    v_mfma_f32_16x16x32_bf16 v[72:75], v[100:103], v[20:23], v[72:75]
    s_waitcnt lgkmcnt(5)
    v_mfma_f32_16x16x32_bf16 v[72:75], v[104:107], v[24:27], v[72:75]
    s_waitcnt lgkmcnt(4)
    v_mfma_f32_16x16x32_bf16 v[72:75], v[108:111], v[28:31], v[72:75]
    s_waitcnt lgkmcnt(3)
    v_mfma_f32_16x16x32_bf16 v[76:79], v[112:115], v[16:19], 0
    s_waitcnt lgkmcnt(2)
    v_mfma_f32_16x16x32_bf16 v[76:79], v[116:119], v[20:23], v[76:79]
    s_waitcnt lgkmcnt(1)
    v_mfma_f32_16x16x32_bf16 v[76:79], v[120:123], v[24:27], v[76:79]
    s_waitcnt lgkmcnt(0)
    v_mfma_f32_16x16x32_bf16 v[76:79], v[124:127], v[28:31], v[76:79]
    s_waitcnt vmcnt(7)
    s_cbranch_vccnz L_go_19
    s_waitcnt vmcnt(5)
    s_cmp_eq_u32 s13, 2
    s_cbranch_scc1 L_go_19
    s_waitcnt vmcnt(4)
    s_cmp_eq_u32 s13, 1
    s_cbranch_scc1 L_go_19
    s_waitcnt vmcnt(3)
L_go_19:
    buffer_load_dwordx4 v[184:187], v5, s[52:55], s10 offen offset:2048 nt
    ds_read_b32 v14, v13 offset:40
    s_waitcnt lgkmcnt(0)
    v_readfirstlane_b32 s13, v14
    s_nop 0
    s_add_u32 s13, s13, 1
    s_cmp_eq_u32 s13, 3
    s_cselect_b64 vcc, -1, 0
    ds_read_b128 v[96:99], v6 offset:16384
    ds_read_b128 v[100:103], v7 offset:16384
    ds_read_b128 v[104:107], v8 offset:16384
    ds_read_b128 v[108:111], v9 offset:16384
    ds_read_b128 v[112:115], v6 offset:20480
    ds_read_b128 v[116:119], v7 offset:20480
    ds_read_b128 v[120:123], v8 offset:20480
    ds_read_b128 v[124:127], v9 offset:20480
    s_waitcnt lgkmcnt(7)
    v_mfma_f32_16x16x32_bf16 v[80:83], v[96:99], v[16:19], 0
    s_waitcnt lgkmcnt(6)
    v_mfma_f32_16x16x32_bf16 v[80:83], v[100:103], v[20:23], v[80:83]
    s_waitcnt lgkmcnt(5)
    v_mfma_f32_16x16x32_bf16 v[80:83], v[104:107], v[24:27], v[80:83]
    s_waitcnt lgkmcnt(4)
    v_mfma_f32_16x16x32_bf16 v[80:83], v[108:111], v[28:31], v[80:83]
    s_waitcnt lgkmcnt(3)
    v_mfma_f32_16x16x32_bf16 v[84:87], v[112:115], v[16:19], 0
    s_waitcnt lgkmcnt(2)
    v_mfma_f32_16x16x32_bf16 v[84:87], v[116:119], v[20:23], v[84:87]
    s_waitcnt lgkmcnt(1)
    v_mfma_f32_16x16x32_bf16 v[84:87], v[120:123], v[24:27], v[84:87]
    s_waitcnt lgkmcnt(0)
    v_mfma_f32_16x16x32_bf16 v[84:87], v[124:127], v[28:31], v[84:87]
    s_waitcnt vmcnt(7)
    s_cbranch_vccnz L_go_20
    s_waitcnt vmcnt(5)
    s_cmp_eq_u32 s13, 2
    s_cbranch_scc1 L_go_20
    s_waitcnt vmcnt(4)
    s_cmp_eq_u32 s13, 1
    s_cbranch_scc1 L_go_20
    s_waitcnt vmcnt(3)
L_go_20:
    buffer_load_dwordx4 v[188:191], v5, s[52:55], s10 offen offset:3072 nt
    ds_read_b128 v[96:99], v6 offset:24576
    ds_read_b128 v[100:103], v7 offset:24576
    ds_read_b128 v[104:107], v8 offset:24576
    ds_read_b128 v[108:111], v9 offset:24576
    ds_read_b128 v[112:115], v6 offset:28672
    ds_read_b128 v[116:119], v7 offset:28672
    ds_read_b128 v[120:123], v8 offset:28672
    ds_read_b128 v[124:127], v9 offset:28672
    s_waitcnt lgkmcnt(7)
    v_mfma_f32_16x16x32_bf16 v[88:91], v[96:99], v[16:19], 0
    s_waitcnt lgkmcnt(6)
    v_mfma_f32_16x16x32_bf16 v[88:91], v[100:103], v[20:23], v[88:91]
    s_waitcnt lgkmcnt(5)
    v_mfma_f32_16x16x32_bf16 v[88:91], v[104:107], v[24:27], v[88:91]
    s_waitcnt lgkmcnt(4)
    v_mfma_f32_16x16x32_bf16 v[88:91], v[108:111], v[28:31], v[88:91]
    s_waitcnt lgkmcnt(3)
    v_mfma_f32_16x16x32_bf16 v[92:95], v[112:115], v[16:19], 0
    s_waitcnt lgkmcnt(2)
    v_mfma_f32_16x16x32_bf16 v[92:95], v[116:119], v[20:23], v[92:95]
    s_waitcnt lgkmcnt(1)
    v_mfma_f32_16x16x32_bf16 v[92:95], v[120:123], v[24:27], v[92:95]
    s_waitcnt lgkmcnt(0)
    v_mfma_f32_16x16x32_bf16 v[92:95], v[124:127], v[28:31], v[92:95]
    s_add_u32 s10, s9, 4194304
    s_waitcnt vmcnt(7)
    s_cbranch_vccnz L_go_21
    s_waitcnt vmcnt(5)
    s_cmp_eq_u32 s13, 2
    s_cbranch_scc1 L_go_21
    s_waitcnt vmcnt(4)
    s_cmp_eq_u32 s13, 1
    s_cbranch_scc1 L_go_21
    s_waitcnt vmcnt(3)
L_go_21:
    buffer_load_dwordx4 v[192:195], v5, s[52:55], s10 offen offset:0 nt
    ds_read_b32 v14, v13 offset:40
    s_waitcnt lgkmcnt(0)
    v_readfirstlane_b32 s13, v14
    s_nop 0
    s_add_u32 s13, s13, 1
    s_cmp_eq_u32 s13, 3
    s_cselect_b64 vcc, -1, 0
    v_cvt_pk_bf16_f32 v64, 0, v64
    v_cvt_pk_bf16_f32 v65, 0, v65
    v_cvt_pk_bf16_f32 v66, 0, v66
    v_cvt_pk_bf16_f32 v67, 0, v67
    v_cvt_pk_bf16_f32 v68, 0, v68
    v_cvt_pk_bf16_f32 v69, 0, v69
    v_cvt_pk_bf16_f32 v70, 0, v70
    v_cvt_pk_bf16_f32 v71, 0, v71
    v_mul_f32 v64, s63, v64
    v_mul_f32 v65, s63, v65
    v_mul_f32 v66, s63, v66
    v_mul_f32 v67, s63, v67
    v_mul_f32 v68, s63, v68
    v_mul_f32 v69, s63, v69
    v_mul_f32 v70, s63, v70
    v_mul_f32 v71, s63, v71
    v_cvt_pk_bf16_f32 v64, 0, v64
    v_cvt_pk_bf16_f32 v65, 0, v65
    v_cvt_pk_bf16_f32 v66, 0, v66
    v_cvt_pk_bf16_f32 v67, 0, v67
    v_cvt_pk_bf16_f32 v68, 0, v68
    v_cvt_pk_bf16_f32 v69, 0, v69
    v_cvt_pk_bf16_f32 v70, 0, v70
    v_cvt_pk_bf16_f32 v71, 0, v71
    v_max3_f32 v15, v64, v65, v15
    v_max3_f32 v15, v66, v67, v15
    v_max3_f32 v15, v68, v69, v15
    v_max3_f32 v15, v70, v71, v15
    v_cvt_pk_bf16_f32 v72, 0, v72
    v_cvt_pk_bf16_f32 v73, 0, v73
    v_cvt_pk_bf16_f32 v74, 0, v74
    v_cvt_pk_bf16_f32 v75, 0, v75
    v_cvt_pk_bf16_f32 v76, 0, v76
    v_cvt_pk_bf16_f32 v77, 0, v77
    v_cvt_pk_bf16_f32 v78, 0, v78
    v_cvt_pk_bf16_f32 v79, 0, v79
    v_mul_f32 v72, s63, v72
    v_mul_f32 v73, s63, v73
    v_mul_f32 v74, s63, v74
    v_mul_f32 v75, s63, v75
    v_mul_f32 v76, s63, v76
    v_mul_f32 v77, s63, v77
    v_mul_f32 v78, s63, v78
    v_mul_f32 v79, s63, v79
    v_cvt_pk_bf16_f32 v72, 0, v72
    v_cvt_pk_bf16_f32 v73, 0, v73
    v_cvt_pk_bf16_f32 v74, 0, v74
    v_cvt_pk_bf16_f32 v75, 0, v75
    v_cvt_pk_bf16_f32 v76, 0, v76
    v_cvt_pk_bf16_f32 v77, 0, v77
    v_cvt_pk_bf16_f32 v78, 0, v78
    v_cvt_pk_bf16_f32 v79, 0, v79
    v_max3_f32 v15, v72, v73, v15
    v_max3_f32 v15, v74, v75, v15
    v_max3_f32 v15, v76, v77, v15
    v_max3_f32 v15, v78, v79, v15
    s_waitcnt vmcnt(7)
    s_cbranch_vccnz L_go_22
    s_waitcnt vmcnt(5)
    s_cmp_eq_u32 s13, 2
    s_cbranch_scc1 L_go_22
    s_waitcnt vmcnt(4)
    s_cmp_eq_u32 s13, 1
    s_cbranch_scc1 L_go_22
    s_waitcnt vmcnt(3)
L_go_22:
    buffer_load_dwordx4 v[196:199], v5, s[52:55], s10 offen offset:1024 nt
    v_cvt_pk_bf16_f32 v80, 0, v80
    v_cvt_pk_bf16_f32 v81, 0, v81
    v_cvt_pk_bf16_f32 v82, 0, v82
    v_cvt_pk_bf16_f32 v83, 0, v83
    v_cvt_pk_bf16_f32 v84, 0, v84
    v_cvt_pk_bf16_f32 v85, 0, v85
    v_cvt_pk_bf16_f32 v86, 0, v86
    v_cvt_pk_bf16_f32 v87, 0, v87
    v_mul_f32 v80, s63, v80
    v_mul_f32 v81, s63, v81
    v_mul_f32 v82, s63, v82
    v_mul_f32 v83, s63, v83
    v_mul_f32 v84, s63, v84
    v_mul_f32 v85, s63, v85
    v_mul_f32 v86, s63, v86
    v_mul_f32 v87, s63, v87
    v_cvt_pk_bf16_f32 v80, 0, v80
    v_cvt_pk_bf16_f32 v81, 0, v81
    v_cvt_pk_bf16_f32 v82, 0, v82
    v_cvt_pk_bf16_f32 v83, 0, v83
    v_cvt_pk_bf16_f32 v84, 0, v84
    v_cvt_pk_bf16_f32 v85, 0, v85
    v_cvt_pk_bf16_f32 v86, 0, v86
    v_cvt_pk_bf16_f32 v87, 0, v87
    v_max3_f32 v15, v80, v81, v15
    v_max3_f32 v15, v82, v83, v15
    v_max3_f32 v15, v84, v85, v15
    v_max3_f32 v15, v86, v87, v15
    v_cvt_pk_bf16_f32 v88, 0, v88
    v_cvt_pk_bf16_f32 v89, 0, v89
    v_cvt_pk_bf16_f32 v90, 0, v90
    v_cvt_pk_bf16_f32 v91, 0, v91
    v_cvt_pk_bf16_f32 v92, 0, v92
    v_cvt_pk_bf16_f32 v93, 0, v93
    v_cvt_pk_bf16_f32 v94, 0, v94
    v_cvt_pk_bf16_f32 v95, 0, v95
    v_mul_f32 v88, s63, v88
    v_mul_f32 v89, s63, v89
    v_mul_f32 v90, s63, v90
    v_mul_f32 v91, s63, v91
    v_mul_f32 v92, s63, v92
    v_mul_f32 v93, s63, v93
    v_mul_f32 v94, s63, v94
    v_mul_f32 v95, s63, v95
    v_cvt_pk_bf16_f32 v88, 0, v88
    v_cvt_pk_bf16_f32 v89, 0, v89
    v_cvt_pk_bf16_f32 v90, 0, v90
    v_cvt_pk_bf16_f32 v91, 0, v91
    v_cvt_pk_bf16_f32 v92, 0, v92
    v_cvt_pk_bf16_f32 v93, 0, v93
    v_cvt_pk_bf16_f32 v94, 0, v94
    v_cvt_pk_bf16_f32 v95, 0, v95
    v_max3_f32 v15, v88, v89, v15
    v_max3_f32 v15, v90, v91, v15
    v_max3_f32 v15, v92, v93, v15
    v_max3_f32 v15, v94, v95, v15
    s_waitcnt vmcnt(7)
    s_cbranch_vccnz L_go_23
    s_waitcnt vmcnt(5)
    s_cmp_eq_u32 s13, 2
    s_cbranch_scc1 L_go_23
    s_waitcnt vmcnt(4)
    s_cmp_eq_u32 s13, 1
    s_cbranch_scc1 L_go_23
    s_waitcnt vmcnt(3)
L_go_23:
    buffer_load_dwordx4 v[200:203], v5, s[52:55], s10 offen offset:2048 nt
    s_waitcnt lgkmcnt(0)
    s_mov_b64 exec, 1
    v_mov_b32 v14, 1
    ds_add_u32 v13, v14 offset:36
    s_mov_b64 exec, -1
    v_mov_b32 v14, v15
    s_nop 1
    v_permlane32_swap_b32 v15, v14
    v_max_f32 v15, v15, v14
    v_mov_b32 v14, v15
    s_nop 1
    v_permlane16_swap_b32 v15, v14
    v_max_f32 v15, v15, v14
    v_mov_b32 v10, v15
    v_mul_f32 v12, s64, v15
    s_waitcnt vmcnt(7)
    s_cbranch_vccnz L_go_24
    s_waitcnt vmcnt(5)
    s_cmp_eq_u32 s13, 2
    s_cbranch_scc1 L_go_24
    s_waitcnt vmcnt(4)
    s_cmp_eq_u32 s13, 1
    s_cbranch_scc1 L_go_24
    s_waitcnt vmcnt(3)
L_go_24:
    buffer_load_dwordx4 v[204:207], v5, s[52:55], s10 offen offset:3072 nt
    v_fma_f32 v32, v32, s64, -v12
    v_fma_f32 v33, v33, s64, -v12
    v_fma_f32 v34, v34, s64, -v12
    v_fma_f32 v35, v35, s64, -v12
    v_fma_f32 v36, v36, s64, -v12
    v_fma_f32 v37, v37, s64, -v12
    v_fma_f32 v38, v38, s64, -v12
    v_fma_f32 v39, v39, s64, -v12
    v_exp_f32 v32, v32
    v_exp_f32 v33, v33
    v_exp_f32 v34, v34
    v_exp_f32 v35, v35
    v_exp_f32 v36, v36
    v_exp_f32 v37, v37
    v_exp_f32 v38, v38
    v_exp_f32 v39, v39
    v_add_f32 v96, v32, v33
    v_add_f32 v97, v34, v35
    v_add_f32 v98, v36, v37
    v_add_f32 v99, v38, v39
    v_cvt_pk_bf16_f32 v32, v32, v33
    v_cvt_pk_bf16_f32 v33, v34, v35
    v_cvt_pk_bf16_f32 v34, v36, v37
    v_cvt_pk_bf16_f32 v35, v38, v39
    v_cndmask_b32 v36, 0, v32, s[70:71]
    v_cndmask_b32 v37, 0, v33, s[70:71]
    v_cndmask_b32 v38, 0, v34, s[70:71]
    v_cndmask_b32 v39, 0, v35, s[70:71]
    v_cndmask_b32 v32, v32, 0, s[70:71]
    v_cndmask_b32 v33, v33, 0, s[70:71]
    v_cndmask_b32 v34, v34, 0, s[70:71]
    v_cndmask_b32 v35, v35, 0, s[70:71]
    v_add_f32 v96, v96, v97
    v_add_f32 v98, v98, v99
    v_add_f32 v11, v96, v98
    s_add_u32 s10, s9, 4198400
    s_waitcnt vmcnt(7)
    s_cbranch_vccnz L_go_25
    s_waitcnt vmcnt(5)
    s_cmp_eq_u32 s13, 2
    s_cbranch_scc1 L_go_25
    s_waitcnt vmcnt(4)
    s_cmp_eq_u32 s13, 1
    s_cbranch_scc1 L_go_25
    s_waitcnt vmcnt(3)
L_go_25:
    buffer_load_dwordx4 v[208:211], v5, s[52:55], s10 offen offset:0 nt
    v_fma_f32 v40, v40, s64, -v12
    v_fma_f32 v41, v41, s64, -v12
    v_fma_f32 v42, v42, s64, -v12
    v_fma_f32 v43, v43, s64, -v12
    v_fma_f32 v44, v44, s64, -v12
    v_fma_f32 v45, v45, s64, -v12
    v_fma_f32 v46, v46, s64, -v12
    v_fma_f32 v47, v47, s64, -v12
    v_exp_f32 v40, v40
    v_exp_f32 v41, v41
    v_exp_f32 v42, v42
    v_exp_f32 v43, v43
    v_exp_f32 v44, v44
    v_exp_f32 v45, v45
    v_exp_f32 v46, v46
    v_exp_f32 v47, v47
    v_add_f32 v96, v40, v41
    v_add_f32 v97, v42, v43
    v_add_f32 v98, v44, v45
    v_add_f32 v99, v46, v47
    v_cvt_pk_bf16_f32 v40, v40, v41
    v_cvt_pk_bf16_f32 v41, v42, v43
    v_cvt_pk_bf16_f32 v42, v44, v45
    v_cvt_pk_bf16_f32 v43, v46, v47
    v_cndmask_b32 v44, 0, v40, s[70:71]
    v_cndmask_b32 v45, 0, v41, s[70:71]
    v_cndmask_b32 v46, 0, v42, s[70:71]
    v_cndmask_b32 v47, 0, v43, s[70:71]
    v_cndmask_b32 v40, v40, 0, s[70:71]
    v_cndmask_b32 v41, v41, 0, s[70:71]
    v_cndmask_b32 v42, v42, 0, s[70:71]
    v_cndmask_b32 v43, v43, 0, s[70:71]
    v_add_f32 v96, v96, v97
    v_add_f32 v98, v98, v99
    v_add_f32 v96, v96, v98
    v_add_f32 v11, v11, v96
    s_waitcnt vmcnt(7)
    s_cbranch_vccnz L_go_26
    s_waitcnt vmcnt(5)
    s_cmp_eq_u32 s13, 2
    s_cbranch_scc1 L_go_26
    s_waitcnt vmcnt(4)
    s_cmp_eq_u32 s13, 1
    s_cbranch_scc1 L_go_26
    s_waitcnt vmcnt(3)
L_go_26:
    buffer_load_dwordx4 v[212:215], v5, s[52:55], s10 offen offset:1024 nt
    ds_read_b32 v14, v13 offset:40
    s_waitcnt lgkmcnt(0)
    v_readfirstlane_b32 s13, v14
    s_nop 0
    s_add_u32 s13, s13, 1
    s_cmp_eq_u32 s13, 3
    s_cselect_b64 vcc, -1, 0
    v_fma_f32 v48, v48, s64, -v12
    v_fma_f32 v49, v49, s64, -v12
    v_fma_f32 v50, v50, s64, -v12
    v_fma_f32 v51, v51, s64, -v12
    v_fma_f32 v52, v52, s64, -v12
    v_fma_f32 v53, v53, s64, -v12
    v_fma_f32 v54, v54, s64, -v12
    v_fma_f32 v55, v55, s64, -v12
    v_exp_f32 v48, v48
    v_exp_f32 v49, v49
    v_exp_f32 v50, v50
    v_exp_f32 v51, v51
    v_exp_f32 v52, v52
    v_exp_f32 v53, v53
    v_exp_f32 v54, v54
    v_exp_f32 v55, v55
    v_add_f32 v96, v48, v49
    v_add_f32 v97, v50, v51
    v_add_f32 v98, v52, v53
    v_add_f32 v99, v54, v55
    v_cvt_pk_bf16_f32 v48, v48, v49
    v_cvt_pk_bf16_f32 v49, v50, v51
    v_cvt_pk_bf16_f32 v50, v52, v53
    v_cvt_pk_bf16_f32 v51, v54, v55
    v_cndmask_b32 v52, 0, v48, s[70:71]
    v_cndmask_b32 v53, 0, v49, s[70:71]
    v_cndmask_b32 v54, 0, v50, s[70:71]
    v_cndmask_b32 v55, 0, v51, s[70:71]
    v_cndmask_b32 v48, v48, 0, s[70:71]
    v_cndmask_b32 v49, v49, 0, s[70:71]
    v_cndmask_b32 v50, v50, 0, s[70:71]
    v_cndmask_b32 v51, v51, 0, s[70:71]
    v_add_f32 v96, v96, v97
    v_add_f32 v98, v98, v99
    v_add_f32 v96, v96, v98
    v_add_f32 v11, v11, v96
    s_waitcnt vmcnt(7)
    s_cbranch_vccnz L_go_27
    s_waitcnt vmcnt(5)
    s_cmp_eq_u32 s13, 2
    s_cbranch_scc1 L_go_27
    s_waitcnt vmcnt(4)
    s_cmp_eq_u32 s13, 1
    s_cbranch_scc1 L_go_27
    s_waitcnt vmcnt(3)
L_go_27:
    buffer_load_dwordx4 v[216:219], v5, s[52:55], s10 offen offset:2048 nt
    v_fma_f32 v56, v56, s64, -v12
    v_fma_f32 v57, v57, s64, -v12
    v_fma_f32 v58, v58, s64, -v12
    v_fma_f32 v59, v59, s64, -v12
    v_fma_f32 v60, v60, s64, -v12
    v_fma_f32 v61, v61, s64, -v12
    v_fma_f32 v62, v62, s64, -v12
    v_fma_f32 v63, v63, s64, -v12
    v_exp_f32 v56, v56
    v_exp_f32 v57, v57
    v_exp_f32 v58, v58
    v_exp_f32 v59, v59
    v_exp_f32 v60, v60
    v_exp_f32 v61, v61
    v_exp_f32 v62, v62
    v_exp_f32 v63, v63
    v_add_f32 v96, v56, v57
    v_add_f32 v97, v58, v59
    v_add_f32 v98, v60, v61
    v_add_f32 v99, v62, v63
    v_cvt_pk_bf16_f32 v56, v56, v57
    v_cvt_pk_bf16_f32 v57, v58, v59
    v_cvt_pk_bf16_f32 v58, v60, v61
    v_cvt_pk_bf16_f32 v59, v62, v63
    v_cndmask_b32 v60, 0, v56, s[70:71]
    v_cndmask_b32 v61, 0, v57, s[70:71]
    v_cndmask_b32 v62, 0, v58, s[70:71]
    v_cndmask_b32 v63, 0, v59, s[70:71]
    v_cndmask_b32 v56, v56, 0, s[70:71]
    v_cndmask_b32 v57, v57, 0, s[70:71]
    v_cndmask_b32 v58, v58, 0, s[70:71]
    v_cndmask_b32 v59, v59, 0, s[70:71]
    v_add_f32 v96, v96, v97
    v_add_f32 v98, v98, v99
    v_add_f32 v96, v96, v98
    v_add_f32 v11, v11, v96
    s_waitcnt vmcnt(7)
    s_cbranch_vccnz L_go_28
    s_waitcnt vmcnt(5)
    s_cmp_eq_u32 s13, 2
    s_cbranch_scc1 L_go_28
    s_waitcnt vmcnt(4)
    s_cmp_eq_u32 s13, 1
    s_cbranch_scc1 L_go_28
    s_waitcnt vmcnt(3)
L_go_28:
    buffer_load_dwordx4 v[220:223], v5, s[52:55], s10 offen offset:3072 nt
    ds_read_b32 v14, v13 offset:40
    s_waitcnt lgkmcnt(0)
    v_readfirstlane_b32 s13, v14
    s_nop 0
    s_add_u32 s13, s13, 1
    s_cmp_eq_u32 s13, 3
    s_cselect_b64 vcc, -1, 0
    v_fma_f32 v64, v64, s64, -v12
    v_fma_f32 v65, v65, s64, -v12
    v_fma_f32 v66, v66, s64, -v12
    v_fma_f32 v67, v67, s64, -v12
    v_fma_f32 v68, v68, s64, -v12
    v_fma_f32 v69, v69, s64, -v12
    v_fma_f32 v70, v70, s64, -v12
    v_fma_f32 v71, v71, s64, -v12
    v_exp_f32 v64, v64
    v_exp_f32 v65, v65
    v_exp_f32 v66, v66
    v_exp_f32 v67, v67
    v_exp_f32 v68, v68
    v_exp_f32 v69, v69
    v_exp_f32 v70, v70
    v_exp_f32 v71, v71
    v_add_f32 v96, v64, v65
    v_add_f32 v97, v66, v67
    v_add_f32 v98, v68, v69
    v_add_f32 v99, v70, v71
    v_cvt_pk_bf16_f32 v64, v64, v65
    v_cvt_pk_bf16_f32 v65, v66, v67
    v_cvt_pk_bf16_f32 v66, v68, v69
    v_cvt_pk_bf16_f32 v67, v70, v71
    v_cndmask_b32 v68, 0, v64, s[70:71]
    v_cndmask_b32 v69, 0, v65, s[70:71]
    v_cndmask_b32 v70, 0, v66, s[70:71]
    v_cndmask_b32 v71, 0, v67, s[70:71]
    v_cndmask_b32 v64, v64, 0, s[70:71]
    v_cndmask_b32 v65, v65, 0, s[70:71]
    v_cndmask_b32 v66, v66, 0, s[70:71]
    v_cndmask_b32 v67, v67, 0, s[70:71]
    v_add_f32 v96, v96, v97
    v_add_f32 v98, v98, v99
    v_add_f32 v96, v96, v98
    v_add_f32 v11, v11, v96
    s_add_u32 s10, s9, 6291456
    s_waitcnt vmcnt(7)
    s_cbranch_vccnz L_go_29
    s_waitcnt vmcnt(5)
    s_cmp_eq_u32 s13, 2
    s_cbranch_scc1 L_go_29
    s_waitcnt vmcnt(4)
    s_cmp_eq_u32 s13, 1
    s_cbranch_scc1 L_go_29
    s_waitcnt vmcnt(3)
L_go_29:
    buffer_load_dwordx4 v[224:227], v5, s[52:55], s10 offen offset:0 nt
    v_fma_f32 v72, v72, s64, -v12
    v_fma_f32 v73, v73, s64, -v12
    v_fma_f32 v74, v74, s64, -v12
    v_fma_f32 v75, v75, s64, -v12
    v_fma_f32 v76, v76, s64, -v12
    v_fma_f32 v77, v77, s64, -v12
    v_fma_f32 v78, v78, s64, -v12
    v_fma_f32 v79, v79, s64, -v12
    v_exp_f32 v72, v72
    v_exp_f32 v73, v73
    v_exp_f32 v74, v74
    v_exp_f32 v75, v75
    v_exp_f32 v76, v76
    v_exp_f32 v77, v77
    v_exp_f32 v78, v78
    v_exp_f32 v79, v79
    v_add_f32 v96, v72, v73
    v_add_f32 v97, v74, v75
    v_add_f32 v98, v76, v77
    v_add_f32 v99, v78, v79
    v_cvt_pk_bf16_f32 v72, v72, v73
    v_cvt_pk_bf16_f32 v73, v74, v75
    v_cvt_pk_bf16_f32 v74, v76, v77
    v_cvt_pk_bf16_f32 v75, v78, v79
    v_cndmask_b32 v76, 0, v72, s[70:71]
    v_cndmask_b32 v77, 0, v73, s[70:71]
    v_cndmask_b32 v78, 0, v74, s[70:71]
    v_cndmask_b32 v79, 0, v75, s[70:71]
    v_cndmask_b32 v72, v72, 0, s[70:71]
    v_cndmask_b32 v73, v73, 0, s[70:71]
    v_cndmask_b32 v74, v74, 0, s[70:71]
    v_cndmask_b32 v75, v75, 0, s[70:71]
    v_add_f32 v96, v96, v97
    v_add_f32 v98, v98, v99
    v_add_f32 v96, v96, v98
    v_add_f32 v11, v11, v96
    s_waitcnt vmcnt(7)
    s_cbranch_vccnz L_go_30
    s_waitcnt vmcnt(5)
    s_cmp_eq_u32 s13, 2
    s_cbranch_scc1 L_go_30
    s_waitcnt vmcnt(4)
    s_cmp_eq_u32 s13, 1
    s_cbranch_scc1 L_go_30
    s_waitcnt vmcnt(3)
L_go_30:
    buffer_load_dwordx4 v[228:231], v5, s[52:55], s10 offen offset:1024 nt
    ds_read_b32 v14, v13 offset:40
    s_waitcnt lgkmcnt(0)
    v_readfirstlane_b32 s13, v14
    s_nop 0
    s_add_u32 s13, s13, 1
    s_cmp_eq_u32 s13, 3
    s_cselect_b64 vcc, -1, 0
    v_fma_f32 v80, v80, s64, -v12
    v_fma_f32 v81, v81, s64, -v12
    v_fma_f32 v82, v82, s64, -v12
    v_fma_f32 v83, v83, s64, -v12
    v_fma_f32 v84, v84, s64, -v12
    v_fma_f32 v85, v85, s64, -v12
    v_fma_f32 v86, v86, s64, -v12
    v_fma_f32 v87, v87, s64, -v12
    v_exp_f32 v80, v80
    v_exp_f32 v81, v81
    v_exp_f32 v82, v82
    v_exp_f32 v83, v83
    v_exp_f32 v84, v84
    v_exp_f32 v85, v85
    v_exp_f32 v86, v86
    v_exp_f32 v87, v87
    v_add_f32 v96, v80, v81
    v_add_f32 v97, v82, v83
    v_add_f32 v98, v84, v85
    v_add_f32 v99, v86, v87
    v_cvt_pk_bf16_f32 v80, v80, v81
    v_cvt_pk_bf16_f32 v81, v82, v83
    v_cvt_pk_bf16_f32 v82, v84, v85
    v_cvt_pk_bf16_f32 v83, v86, v87
    v_cndmask_b32 v84, 0, v80, s[70:71]
    v_cndmask_b32 v85, 0, v81, s[70:71]
    v_cndmask_b32 v86, 0, v82, s[70:71]
    v_cndmask_b32 v87, 0, v83, s[70:71]
    v_cndmask_b32 v80, v80, 0, s[70:71]
    v_cndmask_b32 v81, v81, 0, s[70:71]
    v_cndmask_b32 v82, v82, 0, s[70:71]
    v_cndmask_b32 v83, v83, 0, s[70:71]
    v_add_f32 v96, v96, v97
    v_add_f32 v98, v98, v99
    v_add_f32 v96, v96, v98
    v_add_f32 v11, v11, v96
    s_waitcnt vmcnt(7)
    s_cbranch_vccnz L_go_31
    s_waitcnt vmcnt(5)
    s_cmp_eq_u32 s13, 2
    s_cbranch_scc1 L_go_31
    s_waitcnt vmcnt(4)
    s_cmp_eq_u32 s13, 1
    s_cbranch_scc1 L_go_31
    s_waitcnt vmcnt(3)
L_go_31:
    buffer_load_dwordx4 v[232:235], v5, s[52:55], s10 offen offset:2048 nt
    v_fma_f32 v88, v88, s64, -v12
    v_fma_f32 v89, v89, s64, -v12
    v_fma_f32 v90, v90, s64, -v12
    v_fma_f32 v91, v91, s64, -v12
    v_fma_f32 v92, v92, s64, -v12
    v_fma_f32 v93, v93, s64, -v12
    v_fma_f32 v94, v94, s64, -v12
    v_fma_f32 v95, v95, s64, -v12
    v_exp_f32 v88, v88
    v_exp_f32 v89, v89
    v_exp_f32 v90, v90
    v_exp_f32 v91, v91
    v_exp_f32 v92, v92
    v_exp_f32 v93, v93
    v_exp_f32 v94, v94
    v_exp_f32 v95, v95
    v_add_f32 v96, v88, v89
    v_add_f32 v97, v90, v91
    v_add_f32 v98, v92, v93
    v_add_f32 v99, v94, v95
    v_cvt_pk_bf16_f32 v88, v88, v89
    v_cvt_pk_bf16_f32 v89, v90, v91
    v_cvt_pk_bf16_f32 v90, v92, v93
    v_cvt_pk_bf16_f32 v91, v94, v95
    v_cndmask_b32 v92, 0, v88, s[70:71]
    v_cndmask_b32 v93, 0, v89, s[70:71]
    v_cndmask_b32 v94, 0, v90, s[70:71]
    v_cndmask_b32 v95, 0, v91, s[70:71]
    v_cndmask_b32 v88, v88, 0, s[70:71]
    v_cndmask_b32 v89, v89, 0, s[70:71]
    v_cndmask_b32 v90, v90, 0, s[70:71]
    v_cndmask_b32 v91, v91, 0, s[70:71]
    v_add_f32 v96, v96, v97
    v_add_f32 v98, v98, v99
    v_add_f32 v96, v96, v98
    v_add_f32 v11, v11, v96
    s_waitcnt vmcnt(7)
    s_cbranch_vccnz L_go_32
    s_waitcnt vmcnt(5)
    s_cmp_eq_u32 s13, 2
    s_cbranch_scc1 L_go_32
    s_waitcnt vmcnt(4)
    s_cmp_eq_u32 s13, 1
    s_cbranch_scc1 L_go_32
    s_waitcnt vmcnt(3)
L_go_32:
    buffer_load_dwordx4 v[236:239], v5, s[52:55], s10 offen offset:3072 nt
    s_waitcnt lgkmcnt(0)
    s_mov_b64 exec, 1
    v_mov_b32 v14, 1
    ds_add_u32 v13, v14 offset:36
    s_mov_b64 exec, -1
    v_mov_b32 v14, v11
    s_nop 1
    v_permlane32_swap_b32 v11, v14
    v_add_f32 v11, v11, v14
    v_mov_b32 v14, v11
    s_nop 1
    v_permlane16_swap_b32 v11, v14
    v_add_f32 v11, v11, v14
    v_lshrrev_b32 v14, 1, v5
    s_lshl_b32 s8, s3, 6
    s_add_u32 s8, s8, 131328
    v_add_u32 v14, s8, v14
    s_mov_b64 exec, 0xff
    ds_write_b64 v14, v[10:11]
    s_mov_b64 exec, -1
    s_waitcnt lgkmcnt(0)
    s_mov_b64 exec, 1
    v_mov_b32 v14, 1
    ds_add_u32 v13, v14 offset:8
    s_mov_b64 exec, -1
    s_add_u32 s10, s9, 6295552
    s_waitcnt vmcnt(7)
    s_cbranch_vccnz L_go_33
    s_waitcnt vmcnt(5)
    s_cmp_eq_u32 s13, 2
    s_cbranch_scc1 L_go_33
    s_waitcnt vmcnt(4)
    s_cmp_eq_u32 s13, 1
    s_cbranch_scc1 L_go_33
    s_waitcnt vmcnt(3)
L_go_33:
    buffer_load_dwordx4 v[240:243], v5, s[52:55], s10 offen offset:0 nt
    v_perm_b32 v96, v132, v128, s60
    v_perm_b32 v97, v140, v136, s60
    v_perm_b32 v98, v148, v144, s60
    v_perm_b32 v99, v156, v152, s60
    v_perm_b32 v100, v132, v128, s61
    v_perm_b32 v101, v140, v136, s61
    v_perm_b32 v102, v148, v144, s61
    v_perm_b32 v103, v156, v152, s61
    v_mfma_f32_16x16x32_bf16 v[16:19], v[96:99], v[32:35], 0
    v_perm_b32 v104, v133, v129, s60
    v_perm_b32 v105, v141, v137, s60
    v_perm_b32 v106, v149, v145, s60
    v_perm_b32 v107, v157, v153, s60
    v_mfma_f32_16x16x32_bf16 v[20:23], v[100:103], v[32:35], 0
    v_perm_b32 v108, v133, v129, s61
    v_perm_b32 v109, v141, v137, s61
    v_perm_b32 v110, v149, v145, s61
    v_perm_b32 v111, v157, v153, s61
    v_mfma_f32_16x16x32_bf16 v[24:27], v[104:107], v[32:35], 0
    s_nop 0
    v_mfma_f32_16x16x32_bf16 v[28:31], v[108:111], v[32:35], 0
    s_waitcnt vmcnt(7)
    s_cbranch_vccnz L_go_34
    s_waitcnt vmcnt(5)
    s_cmp_eq_u32 s13, 2
    s_cbranch_scc1 L_go_34
    s_waitcnt vmcnt(4)
    s_cmp_eq_u32 s13, 1
    s_cbranch_scc1 L_go_34
    s_waitcnt vmcnt(3)
L_go_34:
    buffer_load_dwordx4 v[244:247], v5, s[52:55], s10 offen offset:1024 nt
    v_perm_b32 v112, v134, v130, s60
    v_perm_b32 v113, v142, v138, s60
    v_perm_b32 v114, v150, v146, s60
    v_perm_b32 v115, v158, v154, s60
    v_perm_b32 v116, v134, v130, s61
    v_perm_b32 v117, v142, v138, s61
    v_perm_b32 v118, v150, v146, s61
    v_perm_b32 v119, v158, v154, s61
    v_mfma_f32_16x16x32_bf16 v[16:19], v[112:115], v[36:39], v[16:19]
    v_perm_b32 v120, v135, v131, s60
    v_perm_b32 v121, v143, v139, s60
    v_perm_b32 v122, v151, v147, s60
    v_perm_b32 v123, v159, v155, s60
    v_mfma_f32_16x16x32_bf16 v[20:23], v[116:119], v[36:39], v[20:23]
    v_perm_b32 v124, v135, v131, s61
    v_perm_b32 v125, v143, v139, s61
    v_perm_b32 v126, v151, v147, s61
    v_perm_b32 v127, v159, v155, s61
    v_mfma_f32_16x16x32_bf16 v[24:27], v[120:123], v[36:39], v[24:27]
    s_nop 0
    v_mfma_f32_16x16x32_bf16 v[28:31], v[124:127], v[36:39], v[28:31]
    s_waitcnt vmcnt(7)
    s_cbranch_vccnz L_go_35
    s_waitcnt vmcnt(5)
    s_cmp_eq_u32 s13, 2
    s_cbranch_scc1 L_go_35
    s_waitcnt vmcnt(4)
    s_cmp_eq_u32 s13, 1
    s_cbranch_scc1 L_go_35
    s_waitcnt vmcnt(3)
L_go_35:
    buffer_load_dwordx4 v[248:251], v5, s[52:55], s10 offen offset:2048 nt
    ds_read_b32 v14, v13 offset:40
    s_waitcnt lgkmcnt(0)
    v_readfirstlane_b32 s13, v14
    s_nop 0
    s_add_u32 s13, s13, 1
    s_cmp_eq_u32 s13, 3
    s_cselect_b64 vcc, -1, 0
    v_perm_b32 v96, v164, v160, s60
    v_perm_b32 v97, v172, v168, s60
    v_perm_b32 v98, v180, v176, s60
    v_perm_b32 v99, v188, v184, s60
    v_perm_b32 v100, v164, v160, s61
    v_perm_b32 v101, v172, v168, s61
    v_perm_b32 v102, v180, v176, s61
    v_perm_b32 v103, v188, v184, s61
    v_mfma_f32_16x16x32_bf16 v[16:19], v[96:99], v[40:43], v[16:19]
    v_perm_b32 v104, v165, v161, s60
    v_perm_b32 v105, v173, v169, s60
    v_perm_b32 v106, v181, v177, s60
    v_perm_b32 v107, v189, v185, s60
    v_mfma_f32_16x16x32_bf16 v[20:23], v[100:103], v[40:43], v[20:23]
    v_perm_b32 v108, v165, v161, s61
    v_perm_b32 v109, v173, v169, s61
    v_perm_b32 v110, v181, v177, s61
    v_perm_b32 v111, v189, v185, s61
    v_mfma_f32_16x16x32_bf16 v[24:27], v[104:107], v[40:43], v[24:27]
    s_nop 0
    v_mfma_f32_16x16x32_bf16 v[28:31], v[108:111], v[40:43], v[28:31]
    s_waitcnt vmcnt(7)
    s_cbranch_vccnz L_go_36
    s_waitcnt vmcnt(5)
    s_cmp_eq_u32 s13, 2
    s_cbranch_scc1 L_go_36
    s_waitcnt vmcnt(4)
    s_cmp_eq_u32 s13, 1
    s_cbranch_scc1 L_go_36
    s_waitcnt vmcnt(3)
L_go_36:
    buffer_load_dwordx4 v[252:255], v5, s[52:55], s10 offen offset:3072 nt
    v_perm_b32 v112, v166, v162, s60
    v_perm_b32 v113, v174, v170, s60
    v_perm_b32 v114, v182, v178, s60
    v_perm_b32 v115, v190, v186, s60
    v_perm_b32 v116, v166, v162, s61
    v_perm_b32 v117, v174, v170, s61
    v_perm_b32 v118, v182, v178, s61
    v_perm_b32 v119, v190, v186, s61
    v_mfma_f32_16x16x32_bf16 v[16:19], v[112:115], v[44:47], v[16:19]
    v_perm_b32 v120, v167, v163, s60
    v_perm_b32 v121, v175, v171, s60
    v_perm_b32 v122, v183, v179, s60
    v_perm_b32 v123, v191, v187, s60
    v_mfma_f32_16x16x32_bf16 v[20:23], v[116:119], v[44:47], v[20:23]
    v_perm_b32 v124, v167, v163, s61
    v_perm_b32 v125, v175, v171, s61
    v_perm_b32 v126, v183, v179, s61
    v_perm_b32 v127, v191, v187, s61
    v_mfma_f32_16x16x32_bf16 v[24:27], v[120:123], v[44:47], v[24:27]
    s_nop 0
    v_mfma_f32_16x16x32_bf16 v[28:31], v[124:127], v[44:47], v[28:31]
    s_add_u32 s10, s9, 8388608
    s_waitcnt vmcnt(7)
    s_cbranch_vccnz L_go_37
    s_waitcnt vmcnt(5)
    s_cmp_eq_u32 s13, 2
    s_cbranch_scc1 L_go_37
    s_waitcnt vmcnt(4)
    s_cmp_eq_u32 s13, 1
    s_cbranch_scc1 L_go_37
    s_waitcnt vmcnt(3)
L_go_37:
    buffer_load_dwordx4 v[128:131], v5, s[52:55], s10 offen offset:0 nt
    ds_read_b32 v14, v13 offset:40
    s_waitcnt lgkmcnt(0)
    v_readfirstlane_b32 s13, v14
    s_nop 0
    s_add_u32 s13, s13, 1
    s_cmp_eq_u32 s13, 3
    s_cselect_b64 vcc, -1, 0
    v_perm_b32 v96, v196, v192, s60
    v_perm_b32 v97, v204, v200, s60
    v_perm_b32 v98, v212, v208, s60
    v_perm_b32 v99, v220, v216, s60
    v_perm_b32 v100, v196, v192, s61
    v_perm_b32 v101, v204, v200, s61
    v_perm_b32 v102, v212, v208, s61
    v_perm_b32 v103, v220, v216, s61
    v_mfma_f32_16x16x32_bf16 v[16:19], v[96:99], v[48:51], v[16:19]
    v_perm_b32 v104, v197, v193, s60
    v_perm_b32 v105, v205, v201, s60
    v_perm_b32 v106, v213, v209, s60
    v_perm_b32 v107, v221, v217, s60
    v_mfma_f32_16x16x32_bf16 v[20:23], v[100:103], v[48:51], v[20:23]
    v_perm_b32 v108, v197, v193, s61
    v_perm_b32 v109, v205, v201, s61
    v_perm_b32 v110, v213, v209, s61
    v_perm_b32 v111, v221, v217, s61
    v_mfma_f32_16x16x32_bf16 v[24:27], v[104:107], v[48:51], v[24:27]
    s_nop 0
    v_mfma_f32_16x16x32_bf16 v[28:31], v[108:111], v[48:51], v[28:31]
    s_waitcnt vmcnt(7)
    s_cbranch_vccnz L_go_38
    s_waitcnt vmcnt(5)
    s_cmp_eq_u32 s13, 2
    s_cbranch_scc1 L_go_38
    s_waitcnt vmcnt(4)
    s_cmp_eq_u32 s13, 1
    s_cbranch_scc1 L_go_38
    s_waitcnt vmcnt(3)
L_go_38:
    buffer_load_dwordx4 v[132:135], v5, s[52:55], s10 offen offset:1024 nt
    v_perm_b32 v112, v198, v194, s60
    v_perm_b32 v113, v206, v202, s60
    v_perm_b32 v114, v214, v210, s60
    v_perm_b32 v115, v222, v218, s60
    v_perm_b32 v116, v198, v194, s61
    v_perm_b32 v117, v206, v202, s61
    v_perm_b32 v118, v214, v210, s61
    v_perm_b32 v119, v222, v218, s61
    v_mfma_f32_16x16x32_bf16 v[16:19], v[112:115], v[52:55], v[16:19]
    v_perm_b32 v120, v199, v195, s60
    v_perm_b32 v121, v207, v203, s60
    v_perm_b32 v122, v215, v211, s60
    v_perm_b32 v123, v223, v219, s60
    v_mfma_f32_16x16x32_bf16 v[20:23], v[116:119], v[52:55], v[20:23]
    v_perm_b32 v124, v199, v195, s61
    v_perm_b32 v125, v207, v203, s61
    v_perm_b32 v126, v215, v211, s61
    v_perm_b32 v127, v223, v219, s61
    v_mfma_f32_16x16x32_bf16 v[24:27], v[120:123], v[52:55], v[24:27]
    s_nop 0
    v_mfma_f32_16x16x32_bf16 v[28:31], v[124:127], v[52:55], v[28:31]
    s_waitcnt vmcnt(7)
    s_cbranch_vccnz L_go_39
    s_waitcnt vmcnt(5)
    s_cmp_eq_u32 s13, 2
    s_cbranch_scc1 L_go_39
    s_waitcnt vmcnt(4)
    s_cmp_eq_u32 s13, 1
    s_cbranch_scc1 L_go_39
    s_waitcnt vmcnt(3)
L_go_39:
    buffer_load_dwordx4 v[136:139], v5, s[52:55], s10 offen offset:2048 nt
    ds_read_b32 v14, v13 offset:40
    s_waitcnt lgkmcnt(0)
    v_readfirstlane_b32 s13, v14
    s_nop 0
    s_add_u32 s13, s13, 1
    s_cmp_eq_u32 s13, 3
    s_cselect_b64 vcc, -1, 0
    s_waitcnt vmcnt(7)
    s_cbranch_vccnz L_go_40
    s_waitcnt vmcnt(5)
    s_cmp_eq_u32 s13, 2
    s_cbranch_scc1 L_go_40
    s_waitcnt vmcnt(4)
    s_cmp_eq_u32 s13, 1
    s_cbranch_scc1 L_go_40
    s_waitcnt vmcnt(3)
L_go_40:
    buffer_load_dwordx4 v[140:143], v5, s[52:55], s10 offen offset:3072 nt
    s_add_u32 s10, s9, 8392704
    s_waitcnt vmcnt(7)
    s_cbranch_vccnz L_go_41
    s_waitcnt vmcnt(5)
    s_cmp_eq_u32 s13, 2
    s_cbranch_scc1 L_go_41
    s_waitcnt vmcnt(4)
    s_cmp_eq_u32 s13, 1
    s_cbranch_scc1 L_go_41
    s_waitcnt vmcnt(3)
L_go_41:
    buffer_load_dwordx4 v[144:147], v5, s[52:55], s10 offen offset:0 nt
    s_waitcnt lgkmcnt(0)
    s_mov_b64 exec, 1
    v_mov_b32 v14, 1
    ds_add_u32 v13, v14 offset:36
    s_mov_b64 exec, -1
    s_waitcnt vmcnt(5)
    v_perm_b32 v96, v228, v224, s60
    v_perm_b32 v97, v236, v232, s60
    v_perm_b32 v98, v244, v240, s60
    v_perm_b32 v99, v252, v248, s60
    v_perm_b32 v100, v228, v224, s61
    v_perm_b32 v101, v236, v232, s61
    v_perm_b32 v102, v244, v240, s61
    v_perm_b32 v103, v252, v248, s61
    v_mfma_f32_16x16x32_bf16 v[16:19], v[96:99], v[56:59], v[16:19]
    v_perm_b32 v104, v229, v225, s60
    v_perm_b32 v105, v237, v233, s60
    v_perm_b32 v106, v245, v241, s60
    v_perm_b32 v107, v253, v249, s60
    v_mfma_f32_16x16x32_bf16 v[20:23], v[100:103], v[56:59], v[20:23]
    v_perm_b32 v108, v229, v225, s61
    v_perm_b32 v109, v237, v233, s61
    v_perm_b32 v110, v245, v241, s61
    v_perm_b32 v111, v253, v249, s61
    v_mfma_f32_16x16x32_bf16 v[24:27], v[104:107], v[56:59], v[24:27]
    s_nop 0
    v_mfma_f32_16x16x32_bf16 v[28:31], v[108:111], v[56:59], v[28:31]
    s_waitcnt vmcnt(7)
    s_cbranch_vccnz L_go_42
    s_waitcnt vmcnt(5)
    s_cmp_eq_u32 s13, 2
    s_cbranch_scc1 L_go_42
    s_waitcnt vmcnt(4)
    s_cmp_eq_u32 s13, 1
    s_cbranch_scc1 L_go_42
    s_waitcnt vmcnt(3)
L_go_42:
    buffer_load_dwordx4 v[148:151], v5, s[52:55], s10 offen offset:1024 nt
    v_perm_b32 v112, v230, v226, s60
    v_perm_b32 v113, v238, v234, s60
    v_perm_b32 v114, v246, v242, s60
    v_perm_b32 v115, v254, v250, s60
    v_perm_b32 v116, v230, v226, s61
    v_perm_b32 v117, v238, v234, s61
    v_perm_b32 v118, v246, v242, s61
    v_perm_b32 v119, v254, v250, s61
    v_mfma_f32_16x16x32_bf16 v[16:19], v[112:115], v[60:63], v[16:19]
    v_perm_b32 v120, v231, v227, s60
    v_perm_b32 v121, v239, v235, s60
    v_perm_b32 v122, v247, v243, s60
    v_perm_b32 v123, v255, v251, s60
    v_mfma_f32_16x16x32_bf16 v[20:23], v[116:119], v[60:63], v[20:23]
    v_perm_b32 v124, v231, v227, s61
    v_perm_b32 v125, v239, v235, s61
    v_perm_b32 v126, v247, v243, s61
    v_perm_b32 v127, v255, v251, s61
    v_mfma_f32_16x16x32_bf16 v[24:27], v[120:123], v[60:63], v[24:27]
    s_nop 0
    v_mfma_f32_16x16x32_bf16 v[28:31], v[124:127], v[60:63], v[28:31]
    s_waitcnt vmcnt(7)
    s_cbranch_vccnz L_go_43
    s_waitcnt vmcnt(5)
    s_cmp_eq_u32 s13, 2
    s_cbranch_scc1 L_go_43
    s_waitcnt vmcnt(4)
    s_cmp_eq_u32 s13, 1
    s_cbranch_scc1 L_go_43
    s_waitcnt vmcnt(3)
L_go_43:
    buffer_load_dwordx4 v[152:155], v5, s[52:55], s10 offen offset:2048 nt
    s_waitcnt vmcnt(7)
    s_cbranch_vccnz L_go_44
    s_waitcnt vmcnt(5)
    s_cmp_eq_u32 s13, 2
    s_cbranch_scc1 L_go_44
    s_waitcnt vmcnt(4)
    s_cmp_eq_u32 s13, 1
    s_cbranch_scc1 L_go_44
    s_waitcnt vmcnt(3)
L_go_44:
    buffer_load_dwordx4 v[156:159], v5, s[52:55], s10 offen offset:3072 nt
    ds_read_b32 v14, v13 offset:40
    s_waitcnt lgkmcnt(0)
    v_readfirstlane_b32 s13, v14
    s_nop 0
    s_add_u32 s13, s13, 1
    s_cmp_eq_u32 s13, 3
    s_cselect_b64 vcc, -1, 0
    s_add_u32 s10, s9, 10485760
    s_waitcnt vmcnt(7)
    s_cbranch_vccnz L_go_45
    s_waitcnt vmcnt(5)
    s_cmp_eq_u32 s13, 2
    s_cbranch_scc1 L_go_45
    s_waitcnt vmcnt(4)
    s_cmp_eq_u32 s13, 1
    s_cbranch_scc1 L_go_45
    s_waitcnt vmcnt(3)
L_go_45:
    buffer_load_dwordx4 v[160:163], v5, s[52:55], s10 offen offset:0 nt
    s_waitcnt lgkmcnt(0)
    s_mov_b64 exec, 1
    v_mov_b32 v14, 1
    ds_add_u32 v13, v14 offset:12
    s_mov_b64 exec, -1
    s_waitcnt vmcnt(7)
    s_cbranch_vccnz L_go_46
    s_waitcnt vmcnt(5)
    s_cmp_eq_u32 s13, 2
    s_cbranch_scc1 L_go_46
    s_waitcnt vmcnt(4)
    s_cmp_eq_u32 s13, 1
    s_cbranch_scc1 L_go_46
    s_waitcnt vmcnt(3)
L_go_46:
    buffer_load_dwordx4 v[164:167], v5, s[52:55], s10 offen offset:1024 nt
    ds_read_b32 v14, v13 offset:40
    s_waitcnt lgkmcnt(0)
    v_readfirstlane_b32 s13, v14
    s_nop 0
    s_add_u32 s13, s13, 1
    s_cmp_eq_u32 s13, 3
    s_cselect_b64 vcc, -1, 0
    s_waitcnt vmcnt(7)
    s_cbranch_vccnz L_go_47
    s_waitcnt vmcnt(5)
    s_cmp_eq_u32 s13, 2
    s_cbranch_scc1 L_go_47
    s_waitcnt vmcnt(4)
    s_cmp_eq_u32 s13, 1
    s_cbranch_scc1 L_go_47
    s_waitcnt vmcnt(3)
L_go_47:
    buffer_load_dwordx4 v[168:171], v5, s[52:55], s10 offen offset:2048 nt
    s_waitcnt vmcnt(7)
    s_cbranch_vccnz L_go_48
    s_waitcnt vmcnt(5)
    s_cmp_eq_u32 s13, 2
    s_cbranch_scc1 L_go_48
    s_waitcnt vmcnt(4)
    s_cmp_eq_u32 s13, 1
    s_cbranch_scc1 L_go_48
    s_waitcnt vmcnt(3)
L_go_48:
    buffer_load_dwordx4 v[172:175], v5, s[52:55], s10 offen offset:3072 nt
    ds_read_b32 v14, v13 offset:40
    s_waitcnt lgkmcnt(0)
    v_readfirstlane_b32 s13, v14
    s_nop 0
    s_add_u32 s13, s13, 1
    s_cmp_eq_u32 s13, 3
    s_cselect_b64 vcc, -1, 0
    s_add_u32 s10, s9, 10489856
    s_waitcnt vmcnt(7)
    s_cbranch_vccnz L_go_49
    s_waitcnt vmcnt(5)
    s_cmp_eq_u32 s13, 2
    s_cbranch_scc1 L_go_49
    s_waitcnt vmcnt(4)
    s_cmp_eq_u32 s13, 1
    s_cbranch_scc1 L_go_49
    s_waitcnt vmcnt(3)
L_go_49:
    buffer_load_dwordx4 v[176:179], v5, s[52:55], s10 offen offset:0 nt
    s_waitcnt lgkmcnt(0)
    s_mov_b64 exec, 1
    v_mov_b32 v14, 1
    ds_add_u32 v13, v14 offset:36
    s_mov_b64 exec, -1
    s_waitcnt vmcnt(5)
    v_perm_b32 v96, v132, v128, s60
    v_perm_b32 v97, v140, v136, s60
    v_perm_b32 v98, v148, v144, s60
    v_perm_b32 v99, v156, v152, s60
    v_perm_b32 v100, v132, v128, s61
    v_perm_b32 v101, v140, v136, s61
    v_perm_b32 v102, v148, v144, s61
    v_perm_b32 v103, v156, v152, s61
    v_mfma_f32_16x16x32_bf16 v[16:19], v[96:99], v[64:67], v[16:19]
    v_perm_b32 v104, v133, v129, s60
    v_perm_b32 v105, v141, v137, s60
    v_perm_b32 v106, v149, v145, s60
    v_perm_b32 v107, v157, v153, s60
    v_mfma_f32_16x16x32_bf16 v[20:23], v[100:103], v[64:67], v[20:23]
    v_perm_b32 v108, v133, v129, s61
    v_perm_b32 v109, v141, v137, s61
    v_perm_b32 v110, v149, v145, s61
    v_perm_b32 v111, v157, v153, s61
    v_mfma_f32_16x16x32_bf16 v[24:27], v[104:107], v[64:67], v[24:27]
    s_nop 0
    v_mfma_f32_16x16x32_bf16 v[28:31], v[108:111], v[64:67], v[28:31]
    s_waitcnt vmcnt(7)
    s_cbranch_vccnz L_go_50
    s_waitcnt vmcnt(5)
    s_cmp_eq_u32 s13, 2
    s_cbranch_scc1 L_go_50
    s_waitcnt vmcnt(4)
    s_cmp_eq_u32 s13, 1
    s_cbranch_scc1 L_go_50
    s_waitcnt vmcnt(3)
L_go_50:
    buffer_load_dwordx4 v[180:183], v5, s[52:55], s10 offen offset:1024 nt
    v_perm_b32 v112, v134, v130, s60
    v_perm_b32 v113, v142, v138, s60
    v_perm_b32 v114, v150, v146, s60
    v_perm_b32 v115, v158, v154, s60
    v_perm_b32 v116, v134, v130, s61
    v_perm_b32 v117, v142, v138, s61
    v_perm_b32 v118, v150, v146, s61
    v_perm_b32 v119, v158, v154, s61
    v_mfma_f32_16x16x32_bf16 v[16:19], v[112:115], v[68:71], v[16:19]
    v_perm_b32 v120, v135, v131, s60
    v_perm_b32 v121, v143, v139, s60
    v_perm_b32 v122, v151, v147, s60
    v_perm_b32 v123, v159, v155, s60
    v_mfma_f32_16x16x32_bf16 v[20:23], v[116:119], v[68:71], v[20:23]
    v_perm_b32 v124, v135, v131, s61
    v_perm_b32 v125, v143, v139, s61
    v_perm_b32 v126, v151, v147, s61
    v_perm_b32 v127, v159, v155, s61
    v_mfma_f32_16x16x32_bf16 v[24:27], v[120:123], v[68:71], v[24:27]
    s_nop 0
    v_mfma_f32_16x16x32_bf16 v[28:31], v[124:127], v[68:71], v[28:31]
    s_waitcnt vmcnt(7)
    s_cbranch_vccnz L_go_51
    s_waitcnt vmcnt(5)
    s_cmp_eq_u32 s13, 2
    s_cbranch_scc1 L_go_51
    s_waitcnt vmcnt(4)
    s_cmp_eq_u32 s13, 1
    s_cbranch_scc1 L_go_51
    s_waitcnt vmcnt(3)
L_go_51:
    buffer_load_dwordx4 v[184:187], v5, s[52:55], s10 offen offset:2048 nt
    s_waitcnt vmcnt(7)
    s_cbranch_vccnz L_go_52
    s_waitcnt vmcnt(5)
    s_cmp_eq_u32 s13, 2
    s_cbranch_scc1 L_go_52
    s_waitcnt vmcnt(4)
    s_cmp_eq_u32 s13, 1
    s_cbranch_scc1 L_go_52
    s_waitcnt vmcnt(3)
L_go_52:
    buffer_load_dwordx4 v[188:191], v5, s[52:55], s10 offen offset:3072 nt
    ds_read_b32 v14, v13 offset:40
    s_waitcnt lgkmcnt(0)
    v_readfirstlane_b32 s13, v14
    s_nop 0
    s_add_u32 s13, s13, 1
    s_cmp_eq_u32 s13, 3
    s_cselect_b64 vcc, -1, 0
    s_add_u32 s10, s9, 12582912
    s_waitcnt vmcnt(7)
    s_cbranch_vccnz L_go_53
    s_waitcnt vmcnt(5)
    s_cmp_eq_u32 s13, 2
    s_cbranch_scc1 L_go_53
    s_waitcnt vmcnt(4)
    s_cmp_eq_u32 s13, 1
    s_cbranch_scc1 L_go_53
    s_waitcnt vmcnt(3)
L_go_53:
    buffer_load_dwordx4 v[192:195], v5, s[52:55], s10 offen offset:0 nt
    s_waitcnt lgkmcnt(0)
    s_mov_b64 exec, 1
    v_mov_b32 v14, 1
    ds_add_u32 v13, v14 offset:12
    s_mov_b64 exec, -1
    s_waitcnt vmcnt(7)
    s_cbranch_vccnz L_go_54
    s_waitcnt vmcnt(5)
    s_cmp_eq_u32 s13, 2
    s_cbranch_scc1 L_go_54
    s_waitcnt vmcnt(4)
    s_cmp_eq_u32 s13, 1
    s_cbranch_scc1 L_go_54
    s_waitcnt vmcnt(3)
L_go_54:
    buffer_load_dwordx4 v[196:199], v5, s[52:55], s10 offen offset:1024 nt
    ds_read_b32 v14, v13 offset:40
    s_waitcnt lgkmcnt(0)
    v_readfirstlane_b32 s13, v14
    s_nop 0
    s_add_u32 s13, s13, 1
    s_cmp_eq_u32 s13, 3
    s_cselect_b64 vcc, -1, 0
    s_waitcnt vmcnt(7)
    s_cbranch_vccnz L_go_55
    s_waitcnt vmcnt(5)
    s_cmp_eq_u32 s13, 2
    s_cbranch_scc1 L_go_55
    s_waitcnt vmcnt(4)
    s_cmp_eq_u32 s13, 1
    s_cbranch_scc1 L_go_55
    s_waitcnt vmcnt(3)
L_go_55:
    buffer_load_dwordx4 v[200:203], v5, s[52:55], s10 offen offset:2048 nt
    s_waitcnt vmcnt(7)
    s_cbranch_vccnz L_go_56
    s_waitcnt vmcnt(5)
    s_cmp_eq_u32 s13, 2
    s_cbranch_scc1 L_go_56
    s_waitcnt vmcnt(4)
    s_cmp_eq_u32 s13, 1
    s_cbranch_scc1 L_go_56
    s_waitcnt vmcnt(3)
L_go_56:
    buffer_load_dwordx4 v[204:207], v5, s[52:55], s10 offen offset:3072 nt
    ds_read_b32 v14, v13 offset:40
    s_waitcnt lgkmcnt(0)
    v_readfirstlane_b32 s13, v14
    s_nop 0
    s_add_u32 s13, s13, 1
    s_cmp_eq_u32 s13, 3
    s_cselect_b64 vcc, -1, 0
    s_add_u32 s10, s9, 12587008
    s_waitcnt vmcnt(7)
    s_cbranch_vccnz L_go_57
    s_waitcnt vmcnt(5)
    s_cmp_eq_u32 s13, 2
    s_cbranch_scc1 L_go_57
    s_waitcnt vmcnt(4)
    s_cmp_eq_u32 s13, 1
    s_cbranch_scc1 L_go_57
    s_waitcnt vmcnt(3)
L_go_57:
    buffer_load_dwordx4 v[208:211], v5, s[52:55], s10 offen offset:0 nt
    s_waitcnt lgkmcnt(0)
    s_mov_b64 exec, 1
    v_mov_b32 v14, 1
    ds_add_u32 v13, v14 offset:36
    s_mov_b64 exec, -1
    s_waitcnt vmcnt(5)
    v_perm_b32 v96, v164, v160, s60
    v_perm_b32 v97, v172, v168, s60
    v_perm_b32 v98, v180, v176, s60
    v_perm_b32 v99, v188, v184, s60
    v_perm_b32 v100, v164, v160, s61
    v_perm_b32 v101, v172, v168, s61
    v_perm_b32 v102, v180, v176, s61
    v_perm_b32 v103, v188, v184, s61
    v_mfma_f32_16x16x32_bf16 v[16:19], v[96:99], v[72:75], v[16:19]
    v_perm_b32 v104, v165, v161, s60
    v_perm_b32 v105, v173, v169, s60
    v_perm_b32 v106, v181, v177, s60
    v_perm_b32 v107, v189, v185, s60
    v_mfma_f32_16x16x32_bf16 v[20:23], v[100:103], v[72:75], v[20:23]
    v_perm_b32 v108, v165, v161, s61
    v_perm_b32 v109, v173, v169, s61
    v_perm_b32 v110, v181, v177, s61
    v_perm_b32 v111, v189, v185, s61
    v_mfma_f32_16x16x32_bf16 v[24:27], v[104:107], v[72:75], v[24:27]
    s_nop 0
    v_mfma_f32_16x16x32_bf16 v[28:31], v[108:111], v[72:75], v[28:31]
    s_waitcnt vmcnt(7)
    s_cbranch_vccnz L_go_58
    s_waitcnt vmcnt(5)
    s_cmp_eq_u32 s13, 2
    s_cbranch_scc1 L_go_58
    s_waitcnt vmcnt(4)
    s_cmp_eq_u32 s13, 1
    s_cbranch_scc1 L_go_58
    s_waitcnt vmcnt(3)
L_go_58:
    buffer_load_dwordx4 v[212:215], v5, s[52:55], s10 offen offset:1024 nt
    v_perm_b32 v112, v166, v162, s60
    v_perm_b32 v113, v174, v170, s60
    v_perm_b32 v114, v182, v178, s60
    v_perm_b32 v115, v190, v186, s60
    v_perm_b32 v116, v166, v162, s61
    v_perm_b32 v117, v174, v170, s61
    v_perm_b32 v118, v182, v178, s61
    v_perm_b32 v119, v190, v186, s61
    v_mfma_f32_16x16x32_bf16 v[16:19], v[112:115], v[76:79], v[16:19]
    v_perm_b32 v120, v167, v163, s60
    v_perm_b32 v121, v175, v171, s60
    v_perm_b32 v122, v183, v179, s60
    v_perm_b32 v123, v191, v187, s60
    v_mfma_f32_16x16x32_bf16 v[20:23], v[116:119], v[76:79], v[20:23]
    v_perm_b32 v124, v167, v163, s61
    v_perm_b32 v125, v175, v171, s61
    v_perm_b32 v126, v183, v179, s61
    v_perm_b32 v127, v191, v187, s61
    v_mfma_f32_16x16x32_bf16 v[24:27], v[120:123], v[76:79], v[24:27]
    s_nop 0
    v_mfma_f32_16x16x32_bf16 v[28:31], v[124:127], v[76:79], v[28:31]
    s_waitcnt vmcnt(7)
    s_cbranch_vccnz L_go_59
    s_waitcnt vmcnt(5)
    s_cmp_eq_u32 s13, 2
    s_cbranch_scc1 L_go_59
    s_waitcnt vmcnt(4)
    s_cmp_eq_u32 s13, 1
    s_cbranch_scc1 L_go_59
    s_waitcnt vmcnt(3)
L_go_59:
    buffer_load_dwordx4 v[216:219], v5, s[52:55], s10 offen offset:2048 nt
    s_waitcnt vmcnt(7)
    s_cbranch_vccnz L_go_60
    s_waitcnt vmcnt(5)
    s_cmp_eq_u32 s13, 2
    s_cbranch_scc1 L_go_60
    s_waitcnt vmcnt(4)
    s_cmp_eq_u32 s13, 1
    s_cbranch_scc1 L_go_60
    s_waitcnt vmcnt(3)
L_go_60:
    buffer_load_dwordx4 v[220:223], v5, s[52:55], s10 offen offset:3072 nt
    ds_read_b32 v14, v13 offset:40
    s_waitcnt lgkmcnt(0)
    v_readfirstlane_b32 s13, v14
    s_nop 0
    s_add_u32 s13, s13, 1
    s_cmp_eq_u32 s13, 3
    s_cselect_b64 vcc, -1, 0
    s_add_u32 s10, s9, 14680064
    s_waitcnt vmcnt(7)
    s_cbranch_vccnz L_go_61
    s_waitcnt vmcnt(5)
    s_cmp_eq_u32 s13, 2
    s_cbranch_scc1 L_go_61
    s_waitcnt vmcnt(4)
    s_cmp_eq_u32 s13, 1
    s_cbranch_scc1 L_go_61
    s_waitcnt vmcnt(3)
L_go_61:
    buffer_load_dwordx4 v[224:227], v5, s[52:55], s10 offen offset:0 nt
    s_waitcnt vmcnt(7)
    s_cbranch_vccnz L_go_62
    s_waitcnt vmcnt(5)
    s_cmp_eq_u32 s13, 2
    s_cbranch_scc1 L_go_62
    s_waitcnt vmcnt(4)
    s_cmp_eq_u32 s13, 1
    s_cbranch_scc1 L_go_62
    s_waitcnt vmcnt(3)
L_go_62:
    buffer_load_dwordx4 v[228:231], v5, s[52:55], s10 offen offset:1024 nt
    ds_read_b32 v14, v13 offset:40
    s_waitcnt lgkmcnt(0)
    v_readfirstlane_b32 s13, v14
    s_nop 0
    s_add_u32 s13, s13, 1
    s_cmp_eq_u32 s13, 3
    s_cselect_b64 vcc, -1, 0
    s_waitcnt vmcnt(7)
    s_cbranch_vccnz L_go_63
    s_waitcnt vmcnt(5)
    s_cmp_eq_u32 s13, 2
    s_cbranch_scc1 L_go_63
    s_waitcnt vmcnt(4)
    s_cmp_eq_u32 s13, 1
    s_cbranch_scc1 L_go_63
    s_waitcnt vmcnt(3)
L_go_63:
    buffer_load_dwordx4 v[232:235], v5, s[52:55], s10 offen offset:2048 nt
    s_waitcnt vmcnt(7)
    s_cbranch_vccnz L_go_64
    s_waitcnt vmcnt(5)
    s_cmp_eq_u32 s13, 2
    s_cbranch_scc1 L_go_64
    s_waitcnt vmcnt(4)
    s_cmp_eq_u32 s13, 1
    s_cbranch_scc1 L_go_64
    s_waitcnt vmcnt(3)
L_go_64:
    buffer_load_dwordx4 v[236:239], v5, s[52:55], s10 offen offset:3072 nt
    ds_read_b32 v14, v13 offset:40
    s_waitcnt lgkmcnt(0)
    v_readfirstlane_b32 s13, v14
    s_nop 0
    s_add_u32 s13, s13, 1
    s_cmp_eq_u32 s13, 3
    s_cselect_b64 vcc, -1, 0
    s_add_u32 s10, s9, 14684160
    s_waitcnt vmcnt(7)
    s_cbranch_vccnz L_go_65
    s_waitcnt vmcnt(5)
    s_cmp_eq_u32 s13, 2
    s_cbranch_scc1 L_go_65
    s_waitcnt vmcnt(4)
    s_cmp_eq_u32 s13, 1
    s_cbranch_scc1 L_go_65
    s_waitcnt vmcnt(3)
L_go_65:
    buffer_load_dwordx4 v[240:243], v5, s[52:55], s10 offen offset:0 nt
    v_bfe_u32 v52, v0, 4, 1
    s_lshl_b32 s8, s3, 1
    v_add_u32 v52, s8, v52
    v_mul_u32_u24 v48, 528, v52
    v_lshlrev_b32 v52, 4, v52
    v_add_u32 v52, 131584, v52
    v_and_b32 v49, 15, v0
    v_lshl_add_u32 v48, v49, 5, v48
    v_lshrrev_b32 v49, 5, v0
    v_lshl_add_u32 v48, v49, 4, v48
    v_add_u32 v49, 0x10000, v48
    v_and_b32 v4, 7, v0
    v_mul_u32_u24 v50, 528, v4
    v_and_b32 v51, 8, v0
    v_lshl_add_u32 v50, v51, 5, v50
    v_lshlrev_b32 v1, 9, v51
    v_lshrrev_b32 v51, 4, v0
    v_lshl_add_u32 v50, v51, 4, v50
    v_add_u32 v50, s12, v50
    v_lshl_add_u32 v1, v51, 15, v1
    v_lshl_add_u32 v1, v4, 4, v1
    v_lshrrev_b32 v2, 3, v0
    v_lshlrev_b32 v2, 12, v2
    v_lshl_add_u32 v2, v4, 4, v2
    v_and_b32 v3, 16, v0
    v_lshlrev_b32 v3, 4, v3
    v_lshlrev_b32 v4, 2, v4
    s_lshl_b32 s8, s3, 9
    s_add_u32 s8, s8, 156928
    v_add3_u32 v3, v3, v4, s8
    s_and_b32 s6, s2, 7
    s_lshr_b32 s8, s2, 7
    s_lshl1_add_u32 s6, s6, s8
    s_mov_b64 s[48:49], s[66:67]
    s_mov_b32 s50, 0x800000
    s_lshl_b32 s73, s6, 8
    s_lshr_b32 s8, s3, 1
    s_lshl_b32 s8, s8, 7
    s_add_u32 s73, s73, s8
    s_and_b32 s8, s3, 1
    s_lshl2_add_u32 s73, s8, s73
    s_lshl_b32 s73, s73, 11
    s_lshl_b32 s8, s7, 7
    s_add_u32 s73, s73, s8
    s_lshl_b32 s74, s6, 15
    s_lshl_b32 s8, s3, 7
    s_add_u32 s74, s74, s8
    s_add_u32 s74, s74, 1048576
    s_lshl2_add_u32 s8, s4, s3
    s_lshl_b32 s8, s8, 15
    s_lshl_b32 s11, s5, 9
    s_add_u32 s11, s11, s8
    s_add_u32 s11, s11, 1048576
    s_waitcnt vmcnt(7)
    s_cbranch_vccnz L_go_66
    s_waitcnt vmcnt(5)
    s_cmp_eq_u32 s13, 2
    s_cbranch_scc1 L_go_66
    s_waitcnt vmcnt(4)
    s_cmp_eq_u32 s13, 1
    s_cbranch_scc1 L_go_66
    s_waitcnt vmcnt(3)
L_go_66:
    buffer_load_dwordx4 v[244:247], v5, s[52:55], s10 offen offset:1024 nt
    s_waitcnt vmcnt(7)
    s_cbranch_vccnz L_go_67
    s_waitcnt vmcnt(5)
    s_cmp_eq_u32 s13, 2
    s_cbranch_scc1 L_go_67
    s_waitcnt vmcnt(4)
    s_cmp_eq_u32 s13, 1
    s_cbranch_scc1 L_go_67
    s_waitcnt vmcnt(3)
L_go_67:
    buffer_load_dwordx4 v[248:251], v5, s[52:55], s10 offen offset:2048 nt
    s_waitcnt vmcnt(7)
    s_cbranch_vccnz L_go_68
    s_waitcnt vmcnt(5)
    s_cmp_eq_u32 s13, 2
    s_cbranch_scc1 L_go_68
    s_waitcnt vmcnt(4)
    s_cmp_eq_u32 s13, 1
    s_cbranch_scc1 L_go_68
    s_waitcnt vmcnt(3)
L_go_68:
    buffer_load_dwordx4 v[252:255], v5, s[52:55], s10 offen offset:3072 nt
L_endgame:
    s_waitcnt vmcnt(7)
    s_cbranch_vccnz L_go_69
    s_waitcnt vmcnt(5)
    s_cmp_eq_u32 s13, 2
    s_cbranch_scc1 L_go_69
    s_waitcnt vmcnt(4)
    s_cmp_eq_u32 s13, 1
    s_cbranch_scc1 L_go_69
    s_waitcnt vmcnt(3)
L_go_69:
    s_add_u32 s10, s73, 0
    buffer_load_dwordx4 v[128:131], v1, s[48:51], s10 offen nt
    s_waitcnt vmcnt(9)
    v_perm_b32 v96, v196, v192, s60
    v_perm_b32 v97, v204, v200, s60
    v_perm_b32 v98, v212, v208, s60
    v_perm_b32 v99, v220, v216, s60
    v_perm_b32 v100, v196, v192, s61
    v_perm_b32 v101, v204, v200, s61
    v_perm_b32 v102, v212, v208, s61
    v_perm_b32 v103, v220, v216, s61
    v_mfma_f32_16x16x32_bf16 v[16:19], v[96:99], v[80:83], v[16:19]
    v_perm_b32 v104, v197, v193, s60
    v_perm_b32 v105, v205, v201, s60
    v_perm_b32 v106, v213, v209, s60
    v_perm_b32 v107, v221, v217, s60
    v_mfma_f32_16x16x32_bf16 v[20:23], v[100:103], v[80:83], v[20:23]
    v_perm_b32 v108, v197, v193, s61
    v_perm_b32 v109, v205, v201, s61
    v_perm_b32 v110, v213, v209, s61
    v_perm_b32 v111, v221, v217, s61
    v_mfma_f32_16x16x32_bf16 v[24:27], v[104:107], v[80:83], v[24:27]
    s_nop 0
    v_mfma_f32_16x16x32_bf16 v[28:31], v[108:111], v[80:83], v[28:31]
    s_waitcnt vmcnt(7)
    s_cbranch_vccnz L_go_70
    s_waitcnt vmcnt(5)
    s_cmp_eq_u32 s13, 2
    s_cbranch_scc1 L_go_70
    s_waitcnt vmcnt(4)
    s_cmp_eq_u32 s13, 1
    s_cbranch_scc1 L_go_70
    s_waitcnt vmcnt(3)
L_go_70:
    s_add_u32 s10, s73, 16384
    buffer_load_dwordx4 v[132:135], v1, s[48:51], s10 offen nt
    v_perm_b32 v112, v198, v194, s60
    v_perm_b32 v113, v206, v202, s60
    v_perm_b32 v114, v214, v210, s60
    v_perm_b32 v115, v222, v218, s60
    v_perm_b32 v116, v198, v194, s61
    v_perm_b32 v117, v206, v202, s61
    v_perm_b32 v118, v214, v210, s61
    v_perm_b32 v119, v222, v218, s61
    v_mfma_f32_16x16x32_bf16 v[16:19], v[112:115], v[84:87], v[16:19]
    v_perm_b32 v120, v199, v195, s60
    v_perm_b32 v121, v207, v203, s60
    v_perm_b32 v122, v215, v211, s60
    v_perm_b32 v123, v223, v219, s60
    v_mfma_f32_16x16x32_bf16 v[20:23], v[116:119], v[84:87], v[20:23]
    v_perm_b32 v124, v199, v195, s61
    v_perm_b32 v125, v207, v203, s61
    v_perm_b32 v126, v215, v211, s61
    v_perm_b32 v127, v223, v219, s61
    v_mfma_f32_16x16x32_bf16 v[24:27], v[120:123], v[84:87], v[24:27]
    s_nop 0
    v_mfma_f32_16x16x32_bf16 v[28:31], v[124:127], v[84:87], v[28:31]
    s_waitcnt vmcnt(7)
    s_cbranch_vccnz L_go_71
    s_waitcnt vmcnt(5)
    s_cmp_eq_u32 s13, 2
    s_cbranch_scc1 L_go_71
    s_waitcnt vmcnt(4)
    s_cmp_eq_u32 s13, 1
    s_cbranch_scc1 L_go_71
    s_waitcnt vmcnt(3)
L_go_71:
    s_add_u32 s10, s73, 131072
    buffer_load_dwordx4 v[136:139], v1, s[48:51], s10 offen nt
    s_waitcnt vmcnt(9)
    v_perm_b32 v96, v228, v224, s60
    v_perm_b32 v100, v228, v224, s61
    v_perm_b32 v104, v229, v225, s60
    v_perm_b32 v108, v229, v225, s61
    v_perm_b32 v112, v230, v226, s60
    v_perm_b32 v116, v230, v226, s61
    v_perm_b32 v120, v231, v227, s60
    v_perm_b32 v124, v231, v227, s61
    s_waitcnt vmcnt(7)
    v_perm_b32 v97, v236, v232, s60
    v_perm_b32 v101, v236, v232, s61
    v_perm_b32 v105, v237, v233, s60
    v_perm_b32 v109, v237, v233, s61
    v_perm_b32 v113, v238, v234, s60
    v_perm_b32 v117, v238, v234, s61
    v_perm_b32 v121, v239, v235, s60
    v_perm_b32 v125, v239, v235, s61
    s_waitcnt vmcnt(7)
    s_cbranch_vccnz L_go_72
    s_waitcnt vmcnt(5)
    s_cmp_eq_u32 s13, 2
    s_cbranch_scc1 L_go_72
    s_waitcnt vmcnt(4)
    s_cmp_eq_u32 s13, 1
    s_cbranch_scc1 L_go_72
    s_waitcnt vmcnt(3)
L_go_72:
    s_add_u32 s10, s73, 147456
    buffer_load_dwordx4 v[140:143], v1, s[48:51], s10 offen nt
    s_waitcnt vmcnt(6)
    v_perm_b32 v98, v244, v240, s60
    v_perm_b32 v102, v244, v240, s61
    v_perm_b32 v106, v245, v241, s60
    v_perm_b32 v110, v245, v241, s61
    v_perm_b32 v114, v246, v242, s60
    v_perm_b32 v118, v246, v242, s61
    v_perm_b32 v122, v247, v243, s60
    v_perm_b32 v126, v247, v243, s61
    s_waitcnt vmcnt(4)
    v_perm_b32 v99, v252, v248, s60
    v_perm_b32 v115, v254, v250, s60
    v_perm_b32 v103, v252, v248, s61
    v_mfma_f32_16x16x32_bf16 v[16:19], v[96:99], v[88:91], v[16:19]
    v_perm_b32 v119, v254, v250, s61
    v_mfma_f32_16x16x32_bf16 v[16:19], v[112:115], v[92:95], v[16:19]
    v_perm_b32 v107, v253, v249, s60
    v_mfma_f32_16x16x32_bf16 v[20:23], v[100:103], v[88:91], v[20:23]
    v_perm_b32 v123, v255, v251, s60
    v_mfma_f32_16x16x32_bf16 v[20:23], v[116:119], v[92:95], v[20:23]
    v_perm_b32 v111, v253, v249, s61
    v_mfma_f32_16x16x32_bf16 v[24:27], v[104:107], v[88:91], v[24:27]
    v_perm_b32 v127, v255, v251, s61
    v_mfma_f32_16x16x32_bf16 v[24:27], v[120:123], v[92:95], v[24:27]
    v_mfma_f32_16x16x32_bf16 v[28:31], v[108:111], v[88:91], v[28:31]
    v_mfma_f32_16x16x32_bf16 v[28:31], v[124:127], v[92:95], v[28:31]
    s_add_u32 s10, s73, 2048
    buffer_load_dwordx4 v[144:147], v1, s[48:51], s10 offen nt
    s_add_u32 s10, s73, 18432
    buffer_load_dwordx4 v[148:151], v1, s[48:51], s10 offen nt
    ds_write_b128 v50, v[16:19] offset:0
    ds_write_b128 v50, v[20:23] offset:64
    ds_write_b128 v50, v[24:27] offset:128
    s_nop 0
    ds_write_b128 v50, v[28:31] offset:192
    s_add_u32 s10, s73, 133120
    buffer_load_dwordx4 v[152:155], v1, s[48:51], s10 offen nt
    s_add_u32 s10, s73, 149504
    buffer_load_dwordx4 v[156:159], v1, s[48:51], s10 offen nt
    s_waitcnt lgkmcnt(0)
    s_barrier
    ds_read_b128 v[16:19], v52
    ds_read_b128 v[32:35], v48
    ds_read_b128 v[36:39], v48 offset:32768
    ds_read_b128 v[40:43], v49
    ds_read_b128 v[44:47], v49 offset:32768
    s_waitcnt lgkmcnt(3)
    v_pk_mul_f32 v[32:33], v[32:33], v[16:17] op_sel:[0,0] op_sel_hi:[1,0]
    v_pk_mul_f32 v[34:35], v[34:35], v[16:17] op_sel:[0,0] op_sel_hi:[1,0]
    s_waitcnt lgkmcnt(2)
    v_pk_fma_f32 v[32:33], v[36:37], v[16:17], v[32:33] op_sel:[0,1,0] op_sel_hi:[1,1,1]
    v_pk_fma_f32 v[34:35], v[38:39], v[16:17], v[34:35] op_sel:[0,1,0] op_sel_hi:[1,1,1]
    s_waitcnt lgkmcnt(1)
    v_pk_fma_f32 v[32:33], v[40:41], v[18:19], v[32:33] op_sel:[0,0,0] op_sel_hi:[1,0,1]
    v_pk_fma_f32 v[34:35], v[42:43], v[18:19], v[34:35] op_sel:[0,0,0] op_sel_hi:[1,0,1]
    s_waitcnt lgkmcnt(0)
    v_pk_fma_f32 v[32:33], v[44:45], v[18:19], v[32:33] op_sel:[0,1,0] op_sel_hi:[1,1,1]
    v_pk_fma_f32 v[34:35], v[46:47], v[18:19], v[34:35] op_sel:[0,1,0] op_sel_hi:[1,1,1]
    v_cvt_pk_bf16_f32 v24, v32, v33
    v_cvt_pk_bf16_f32 v25, v34, v35
    v_min_u32 v24, -2, v24
    v_min_u32 v25, -2, v25
    s_nop 0
    v_permlane32_swap_b32 v24, v26
    v_permlane32_swap_b32 v25, v27
    s_mov_b32 exec_hi, 0
    buffer_store_dwordx4 v[24:27], v5, s[56:59], s11 offen sc1
    s_mov_b64 exec, -1
    v_lshrrev_b32 v4, 4, v0
    v_and_b32 v5, 15, v0
    v_lshrrev_b32 v9, 5, v0
    s_movk_i32 s76, 0x1111
    s_mov_b32 s77, s76
    v_lshl_add_u32 v229, v0, 4, v13
    v_lshlrev_b32 v230, 2, v5
    v_lshl_add_u32 v230, v9, 6, v230
    s_lshl_b32 s72, s6, 11
    s_lshl_b32 s8, s7, 7
    s_add_u32 s72, s72, s8
    s_add_u32 s72, s72, 786432
    v_and_b32 v7, 1, v5
    v_lshlrev_b32 v7, 4, v7
    v_mov_b32 v8, 0x3f80
    v_lshlrev_b32 v7, v7, v8
    v_and_b32 v8, 14, v5
    v_cmp_eq_u32 vcc, 0, v8
    s_nop 1
    v_cndmask_b32 v232, 0, v7, vcc
    v_cmp_eq_u32 vcc, 4, v8
    s_nop 1
    v_cndmask_b32 v233, 0, v7, vcc
    v_cmp_eq_u32 vcc, 8, v8
    s_nop 1
    v_cndmask_b32 v234, 0, v7, vcc
    v_cmp_eq_u32 vcc, 12, v8
    s_nop 1
    v_cndmask_b32 v235, 0, v7, vcc
    v_lshlrev_b32 v244, 13, v4
    v_lshl_add_u32 v244, v5, 4, v244
    v_lshrrev_b32 v6, 3, v5
    v_lshlrev_b32 v6, 6, v6
    v_and_b32 v8, 1, v4
    v_lshl_add_u32 v6, v8, 5, v6
    v_and_b32 v8, 4, v5
    v_lshl_add_u32 v6, v8, 2, v6
    v_and_b32 v8, 3, v5
    v_lshl_add_u32 v6, v8, 1, v6
    v_lshrrev_b32 v8, 1, v4
    s_lshl_b32 s8, s3, 7
    v_add3_u32 v6, v6, v8, s8
    v_lshlrev_b32 v238, 1, v6
    v_mad_u32_u24 v228, v9, 14, v238
    s_and_b32 s8, s2, 0xc7
    s_cmp_lg_u32 s8, 0
    s_cbranch_scc1 L_noprep_73
    v_mov_b32 v231, 0x02020202
    v_mul_lo_u32 v231, v231, v9
    v_add_u32 v231, s60, v231
    v_add_u32 v7, v13, v238
    ds_read_u16 v248, v7 offset:3072
    ds_read_u16 v249, v7 offset:3088
    ds_read_u16 v250, v7 offset:5120
    ds_read_u16 v251, v7 offset:5136
    ds_read_u16 v252, v7 offset:7168
    ds_read_u16 v253, v7 offset:7184
    ds_read_u16 v254, v7 offset:9216
    ds_read_u16 v255, v7 offset:9232
    ds_read_u16 v236, v7 offset:11264
    ds_read_u16 v237, v7 offset:11280
    s_lshl_b32 s75, s3, 8
    s_add_u32 s75, s75, 786432
    s_add_u32 s73, s75, 4096
    s_mov_b32 s66, 0x3a800000
    s_mov_b32 s67, s66
    v_lshlrev_b32 v246, 2, v9
    s_lshl_b32 s8, s3, 3
    v_add3_u32 v246, s8, v246, v13
    v_mov_b32 v245, 5120
    v_mov_b32 v247, 154624
    s_mov_b32 s68, 116224
    s_mov_b32 s69, 0x3727c5ac
    s_mov_b32 s78, 0x10000
    s_mov_b32 s79, s78
    s_mov_b32 s70, 0x11111111
    s_mov_b32 s71, s70
    s_waitcnt lgkmcnt(0)
    v_lshlrev_b32 v248, 16, v248
    v_lshlrev_b32 v249, 16, v249
    v_lshlrev_b32 v250, 16, v250
    v_lshlrev_b32 v251, 16, v251
    v_lshlrev_b32 v252, 16, v252
    v_lshlrev_b32 v253, 16, v253
    v_lshlrev_b32 v254, 16, v254
    v_lshlrev_b32 v255, 16, v255
    v_lshlrev_b32 v236, 16, v236
    v_lshlrev_b32 v237, 16, v237
    v_add_f32 v254, 1.0, v254
    v_add_f32 v255, 1.0, v255
    v_cvt_pk_bf16_f32 v254, 0, v254
    v_cvt_pk_bf16_f32 v255, 0, v255
    s_lshl_b32 s8, s3, 5
    s_add_u32 s8, s8, 159232
    v_lshl_add_u32 v246, v4, 3, s8
    v_and_b32 v8, 7, v0
    v_lshlrev_b32 v8, 5, v8
    v_lshl_add_u32 v239, v4, 3, v8
    v_add_u32 v239, 159232, v239
    s_mov_b32 s78, 0x10001
    s_mov_b32 s79, s78
    v_add_f32 v44, v254, v255
    v_mul_f32 v45, v254, v254
    v_fmac_f32 v45, v255, v255
    v_add_f32 v46, v252, v253
    v_mul_f32 v47, v252, v252
    v_fmac_f32 v47, v253, v253
    v_mul_f32 v48, v254, v252
    v_fmac_f32 v48, v255, v253
    v_mov_b32 v49, 0
    v_permlane32_swap_b32 v44, v45
    v_permlane32_swap_b32 v46, v47
    v_permlane32_swap_b32 v48, v49
    v_add_f32 v44, v44, v45
    v_add_f32 v46, v46, v47
    v_add_f32 v48, v48, v49
    s_nop 0
    v_permlane16_swap_b32 v44, v46
    v_add_f32 v44, v44, v46
    v_add_f32_dpp v48, v48, v48 row_ror:8 row_mask:0xf bank_mask:0xf
    s_nop 0
    v_add_f32_dpp v44, v44, v44 row_ror:8 row_mask:0xf bank_mask:0xf
    v_add_f32_dpp v48, v48, v48 row_ror:4 row_mask:0xf bank_mask:0xf
    s_nop 0
    v_add_f32_dpp v44, v44, v44 row_ror:4 row_mask:0xf bank_mask:0xf
    v_add_f32_dpp v48, v48, v48 row_ror:2 row_mask:0xf bank_mask:0xf
    s_nop 0
    v_add_f32_dpp v44, v44, v44 row_ror:2 row_mask:0xf bank_mask:0xf
    v_add_f32_dpp v48, v48, v48 row_ror:1 row_mask:0xf bank_mask:0xf
    s_nop 0
    v_add_f32_dpp v44, v44, v44 row_ror:1 row_mask:0xf bank_mask:0xf
    s_mov_b64 exec, s[78:79]
    ds_write2_b32 v246, v44, v48 offset0:64 offset1:65
    s_mov_b64 exec, -1
    s_waitcnt lgkmcnt(0)
L_noprep_73:
    s_waitcnt vmcnt(1)
    v_perm_b32 v192, v132, v128, s60
    v_perm_b32 v193, v140, v136, s60
    v_perm_b32 v194, v148, v144, s60
    v_perm_b32 v195, v156, v152, s60
    v_perm_b32 v196, v132, v128, s61
    v_perm_b32 v197, v140, v136, s61
    v_perm_b32 v198, v148, v144, s61
    v_perm_b32 v199, v156, v152, s61
    v_perm_b32 v200, v133, v129, s60
    v_perm_b32 v201, v141, v137, s60
    v_perm_b32 v202, v149, v145, s60
    v_perm_b32 v203, v157, v153, s60
    v_perm_b32 v204, v133, v129, s61
    v_perm_b32 v205, v141, v137, s61
    v_perm_b32 v206, v149, v145, s61
    v_perm_b32 v207, v157, v153, s61
    v_perm_b32 v208, v134, v130, s60
    v_perm_b32 v209, v142, v138, s60
    v_perm_b32 v210, v150, v146, s60
    v_perm_b32 v211, v158, v154, s60
    v_perm_b32 v212, v134, v130, s61
    v_perm_b32 v213, v142, v138, s61
    v_perm_b32 v214, v150, v146, s61
    v_perm_b32 v215, v158, v154, s61
    v_perm_b32 v216, v135, v131, s60
    v_perm_b32 v217, v143, v139, s60
    v_perm_b32 v218, v151, v147, s60
    v_perm_b32 v219, v159, v155, s60
    v_perm_b32 v220, v135, v131, s61
    v_perm_b32 v221, v143, v139, s61
    v_perm_b32 v222, v151, v147, s61
    v_perm_b32 v223, v159, v155, s61
    s_waitcnt vmcnt(0)
    buffer_load_dwordx4 v[160:163], v2, s[56:59], s74 offen offset:0 sc1
    buffer_load_dwordx4 v[164:167], v2, s[56:59], s74 offen offset:512 sc1
    buffer_load_dwordx4 v[168:171], v2, s[56:59], s74 offen offset:1024 sc1
    buffer_load_dwordx4 v[172:175], v2, s[56:59], s74 offen offset:1536 sc1
    buffer_load_dwordx4 v[176:179], v2, s[56:59], s74 offen offset:2048 sc1
    buffer_load_dwordx4 v[180:183], v2, s[56:59], s74 offen offset:2560 sc1
    buffer_load_dwordx4 v[184:187], v2, s[56:59], s74 offen offset:3072 sc1
    buffer_load_dwordx4 v[188:191], v2, s[56:59], s74 offen offset:3584 sc1
    s_mov_b32 s14, 0
L_t1_chk:
    s_waitcnt vmcnt(7)
    v_max3_u32 v6, v160, v161, v162
    v_max_u32 v6, v6, v163
    v_mfma_f32_16x16x32_bf16 v[60:63], v[232:235], v[160:163], 0
    v_cmp_eq_u32 s[16:17], -1, v6
    s_waitcnt vmcnt(6)
    v_max3_u32 v6, v164, v165, v166
    v_max_u32 v6, v6, v167
    v_mfma_f32_16x16x32_bf16 v[60:63], v[232:235], v[164:167], v[60:63]
    v_cmp_eq_u32 s[18:19], -1, v6
    s_waitcnt vmcnt(5)
    v_max3_u32 v6, v168, v169, v170
    v_max_u32 v6, v6, v171
    v_mfma_f32_16x16x32_bf16 v[60:63], v[232:235], v[168:171], v[60:63]
    v_cmp_eq_u32 s[20:21], -1, v6
    s_or_b64 vcc, s[16:17], s[18:19]
    s_waitcnt vmcnt(4)
    v_max3_u32 v6, v172, v173, v174
    v_max_u32 v6, v6, v175
    v_mfma_f32_16x16x32_bf16 v[60:63], v[232:235], v[172:175], v[60:63]
    v_cmp_eq_u32 s[22:23], -1, v6
    s_or_b64 vcc, vcc, s[20:21]
    s_waitcnt vmcnt(3)
    v_max3_u32 v6, v176, v177, v178
    v_max_u32 v6, v6, v179
    v_mfma_f32_16x16x32_bf16 v[60:63], v[232:235], v[176:179], v[60:63]
    v_cmp_eq_u32 s[24:25], -1, v6
    s_or_b64 vcc, vcc, s[22:23]
    s_waitcnt vmcnt(2)
    v_max3_u32 v6, v180, v181, v182
    v_max_u32 v6, v6, v183
    v_mfma_f32_16x16x32_bf16 v[60:63], v[232:235], v[180:183], v[60:63]
    v_cmp_eq_u32 s[26:27], -1, v6
    s_or_b64 vcc, vcc, s[24:25]
    s_waitcnt vmcnt(1)
    v_max3_u32 v6, v184, v185, v186
    v_max_u32 v6, v6, v187
    v_mfma_f32_16x16x32_bf16 v[60:63], v[232:235], v[184:187], v[60:63]
    v_cmp_eq_u32 s[36:37], -1, v6
    s_or_b64 vcc, vcc, s[26:27]
    s_waitcnt vmcnt(0)
    v_max3_u32 v6, v188, v189, v190
    v_max_u32 v6, v6, v191
    v_mfma_f32_16x16x32_bf16 v[60:63], v[232:235], v[188:191], v[60:63]
    v_cmp_eq_u32 s[38:39], -1, v6
    s_or_b64 vcc, vcc, s[36:37]
    s_or_b64 vcc, vcc, s[38:39]
    s_cbranch_scc1 L_t1_retry
L_t1_done:
    s_nop 3
    v_add_f32_dpp v60, v60, v60 row_ror:8 row_mask:0xf bank_mask:0xf
    v_add_f32_dpp v61, v61, v61 row_ror:8 row_mask:0xf bank_mask:0xf
    v_cvt_pk_bf16_f32 v60, v60, v61
    s_nop 1
    v_mov_b32_dpp v224, v60 quad_perm:[0,0,0,0] row_mask:0xf bank_mask:0xf
    v_mov_b32_dpp v225, v60 quad_perm:[1,1,1,1] row_mask:0xf bank_mask:0xf
    v_mov_b32_dpp v226, v60 quad_perm:[2,2,2,2] row_mask:0xf bank_mask:0xf
    v_mov_b32_dpp v227, v60 quad_perm:[3,3,3,3] row_mask:0xf bank_mask:0xf
    s_nop 1
    v_mfma_f32_16x16x32_bf16 v[64:67], v[224:227], v[192:195], 0
    v_mfma_f32_16x16x32_bf16 v[68:71], v[224:227], v[196:199], 0
    v_mfma_f32_16x16x32_bf16 v[72:75], v[224:227], v[200:203], 0
    v_mfma_f32_16x16x32_bf16 v[76:79], v[224:227], v[204:207], 0
    v_mfma_f32_16x16x32_bf16 v[80:83], v[224:227], v[208:211], 0
    v_mfma_f32_16x16x32_bf16 v[84:87], v[224:227], v[212:215], 0
    v_mfma_f32_16x16x32_bf16 v[88:91], v[224:227], v[216:219], 0
    v_mfma_f32_16x16x32_bf16 v[92:95], v[224:227], v[220:223], 0
    s_mov_b32 exec_lo, 0xff0000ff
    s_mov_b32 exec_hi, 0
    ds_write2_b32 v3, v64, v68 offset0:0 offset1:8
    s_nop 0
    ds_write2_b32 v3, v72, v76 offset0:16 offset1:24
    s_nop 0
    ds_write2_b32 v3, v80, v84 offset0:32 offset1:40
    s_nop 0
    ds_write2_b32 v3, v88, v92 offset0:48 offset1:56
    s_mov_b64 exec, -1
    s_waitcnt lgkmcnt(0)
L_tail:
    s_cmp_ge_u32 s3, 1
    s_barrier
    s_cbranch_scc1 L_norep
    ds_read_b128 v[16:19], v229 offset:25856
    ds_read_b128 v[20:23], v229 offset:26880
    s_waitcnt lgkmcnt(0)
    v_pk_add_f32 v[16:17], v[16:17], v[20:21]
    v_pk_add_f32 v[18:19], v[18:19], v[22:23]
    s_nop 1
    v_permlane32_swap_b32 v16, v18
    v_permlane32_swap_b32 v17, v19
    v_pk_add_f32 v[16:17], v[16:17], v[18:19]
    v_mov_b32 v18, v16
    v_mov_b32 v19, v17
    s_nop 0
    v_permlane16_swap_b32 v16, v18
    v_permlane16_swap_b32 v17, v19
    v_pk_add_f32 v[16:17], v[16:17], v[18:19]
    v_cvt_pk_bf16_f32 v16, v16, v17
    v_min_u32 v16, -2, v16
    s_nop 1
    v_mov_b32_dpp v17, v16 quad_perm:[1,1,1,1] row_mask:0xf bank_mask:0xf
    v_mov_b32_dpp v18, v16 quad_perm:[2,2,2,2] row_mask:0xf bank_mask:0xf
    v_mov_b32_dpp v19, v16 quad_perm:[3,3,3,3] row_mask:0xf bank_mask:0xf
    s_mov_b64 exec, s[76:77]
    buffer_store_dwordx4 v[16:19], v230, s[56:59], s72 offen sc1
    s_mov_b64 exec, -1
L_norep:
    s_and_b32 s8, s2, 0xc7
    s_cmp_lg_u32 s8, 0
    s_cbranch_scc1 L_pref
    s_waitcnt vmcnt(0)
    s_barrier
    buffer_load_dwordx4 v[16:19], v244, s[56:59], s75 offen offset:0 sc1
    buffer_load_dwordx4 v[20:23], v244, s[56:59], s75 offen offset:2048 sc1
    buffer_load_dwordx4 v[24:27], v244, s[56:59], s73 offen offset:0 sc1
    buffer_load_dwordx4 v[28:31], v244, s[56:59], s73 offen offset:2048 sc1
    ds_read_b64 v[44:45], v239 offset:256
    s_waitcnt lgkmcnt(0)
    v_mov_b32 v50, s66
    v_add_f32_dpp v45, v45, v45 row_ror:4 row_mask:0xf bank_mask:0xf
    v_add_f32_dpp v44, v44, v44 row_ror:4 row_mask:0xf bank_mask:0xf
    s_nop 0
    v_add_f32_dpp v45, v45, v45 row_ror:2 row_mask:0xf bank_mask:0xf
    v_add_f32_dpp v44, v44, v44 row_ror:2 row_mask:0xf bank_mask:0xf
    s_nop 0
    v_add_f32_dpp v45, v45, v45 row_ror:1 row_mask:0xf bank_mask:0xf
    v_add_f32_dpp v44, v44, v44 row_ror:1 row_mask:0xf bank_mask:0xf
    s_nop 0
    v_add_f32_dpp v45, v45, v45 row_bcast:15 row_mask:0xa bank_mask:0xf
    v_readlane_b32 s48, v44, 0
    v_readlane_b32 s49, v44, 32
    v_readlane_b32 s50, v44, 16
    v_readlane_b32 s51, v44, 48
    v_readlane_b32 s52, v45, 16
    v_readlane_b32 s53, v45, 48
    v_mul_f32 v52, s48, v50
    v_mul_f32 v53, s49, v50
    v_mul_f32 v54, s50, v50
    v_mul_f32 v55, s51, v50
    v_mul_f32 v56, s52, v50
    s_mov_b32 s14, 0
L_t2_chk:
    s_waitcnt vmcnt(3)
    v_max3_u32 v6, v16, v17, v18
    v_max_u32 v6, v6, v19
    v_mfma_f32_16x16x32_bf16 v[240:243], v[232:235], v[16:19], 0
    v_cmp_eq_u32 s[16:17], -1, v6
    s_waitcnt vmcnt(2)
    v_max3_u32 v6, v20, v21, v22
    v_max_u32 v6, v6, v23
    v_mfma_f32_16x16x32_bf16 v[240:243], v[232:235], v[20:23], v[240:243]
    v_cmp_eq_u32 s[18:19], -1, v6
    s_waitcnt vmcnt(1)
    v_max3_u32 v6, v24, v25, v26
    v_max_u32 v6, v6, v27
    v_mfma_f32_16x16x32_bf16 v[240:243], v[232:235], v[24:27], v[240:243]
    v_cmp_eq_u32 s[20:21], -1, v6
    s_or_b64 vcc, s[16:17], s[18:19]
    s_waitcnt vmcnt(0)
    v_max3_u32 v6, v28, v29, v30
    v_max_u32 v6, v6, v31
    v_mfma_f32_16x16x32_bf16 v[240:243], v[232:235], v[28:31], v[240:243]
    v_cmp_eq_u32 s[22:23], -1, v6
    s_or_b64 vcc, vcc, s[20:21]
    s_or_b64 vcc, vcc, s[22:23]
    s_cbranch_scc1 L_t2_retry
L_t2_done:
    s_nop 3
    v_pk_fma_f32 v[240:241], v[250:251], v[240:241], v[248:249]
    v_pk_mul_f32 v[42:43], v[240:241], v[254:255]
    v_add_f32 v44, v240, v241
    v_mul_f32 v45, v240, v240
    v_add_f32 v46, v42, v43
    v_mul_f32 v47, v42, v42
    v_mul_f32 v48, v42, v254
    v_mul_f32 v49, v42, v252
    v_fmac_f32 v45, v241, v241
    v_fmac_f32 v47, v43, v43
    v_fmac_f32 v48, v43, v255
    v_fmac_f32 v49, v43, v253
    v_permlane32_swap_b32 v44, v45
    v_permlane32_swap_b32 v46, v47
    v_permlane32_swap_b32 v48, v49
    v_add_f32 v44, v44, v45
    v_add_f32 v46, v46, v47
    v_add_f32 v48, v48, v49
    s_nop 0
    v_permlane16_swap_b32 v44, v46
    v_add_f32 v44, v44, v46
    v_add_f32_dpp v48, v48, v48 row_ror:8 row_mask:0xf bank_mask:0xf
    s_nop 0
    v_add_f32_dpp v44, v44, v44 row_ror:8 row_mask:0xf bank_mask:0xf
    v_add_f32_dpp v48, v48, v48 row_ror:4 row_mask:0xf bank_mask:0xf
    s_nop 0
    v_add_f32_dpp v44, v44, v44 row_ror:4 row_mask:0xf bank_mask:0xf
    v_add_f32_dpp v48, v48, v48 row_ror:2 row_mask:0xf bank_mask:0xf
    s_nop 0
    v_add_f32_dpp v44, v44, v44 row_ror:2 row_mask:0xf bank_mask:0xf
    v_add_f32_dpp v48, v48, v48 row_ror:1 row_mask:0xf bank_mask:0xf
    s_nop 0
    v_add_f32_dpp v44, v44, v44 row_ror:1 row_mask:0xf bank_mask:0xf
    s_mov_b64 exec, s[78:79]
    ds_write2_b32 v246, v44, v48 offset0:0 offset1:1
    s_mov_b64 exec, -1
    v_mov_b32 v16, 0
    v_mov_b32 v17, 0
    s_lshr_b32 s8, s2, 3
    s_xor_b32 s8, s8, s3
    s_and_b32 s8, s8, 7
    s_waitcnt lgkmcnt(0)
    s_barrier
    s_cbranch_scc1 L_early
    ds_read_b64 v[44:45], v239 offset:0
    s_waitcnt lgkmcnt(0)
    v_mov_b32 v50, s66
    v_add_f32_dpp v45, v45, v45 row_ror:4 row_mask:0xf bank_mask:0xf
    v_add_f32_dpp v44, v44, v44 row_ror:4 row_mask:0xf bank_mask:0xf
    s_nop 0
    v_add_f32_dpp v45, v45, v45 row_ror:2 row_mask:0xf bank_mask:0xf
    v_add_f32_dpp v44, v44, v44 row_ror:2 row_mask:0xf bank_mask:0xf
    s_nop 0
    v_add_f32_dpp v45, v45, v45 row_ror:1 row_mask:0xf bank_mask:0xf
    v_add_f32_dpp v44, v44, v44 row_ror:1 row_mask:0xf bank_mask:0xf
    s_nop 0
    v_add_f32_dpp v45, v45, v45 row_bcast:15 row_mask:0xa bank_mask:0xf
    v_readlane_b32 s48, v44, 0
    v_readlane_b32 s49, v44, 32
    v_readlane_b32 s50, v44, 16
    v_readlane_b32 s51, v44, 48
    v_readlane_b32 s52, v45, 16
    v_readlane_b32 s53, v45, 48
    v_mul_f32 v46, s48, v50
    v_mul_f32 v47, s49, v50
    v_mul_f32 v44, s50, v50
    v_mul_f32 v45, s51, v50
    v_fma_f32 v47, -v46, v46, v47
    v_mul_f32 v48, s52, v50
    v_mul_f32 v49, s53, v50
    v_add_f32 v47, s69, abs(v47)
    v_fma_f32 v44, -v46, v52, v44
    v_rsq_f32 v47, v47
    v_mul_f32 v48, -2.0, v48
    v_fma_f32 v49, -v46, v56, v49
    v_fmac_f32 v48, v46, v53
    v_pk_fma_f32 v[42:43], v[254:255], v[46:47], v[42:43] op_sel:[0,0,0] op_sel_hi:[1,0,1] neg_lo:[0,1,0] neg_hi:[0,1,0]
    v_fmac_f32 v45, v46, v48
    v_add_f32 v49, v49, v49
    v_fma_f32 v44, v44, v47, v54
    v_fmac_f32 v49, v45, v47
    v_pk_fma_f32 v[42:43], v[42:43], v[46:47], v[252:253] op_sel:[0,1,0] op_sel_hi:[1,1,1]
    v_fma_f32 v45, v49, v47, v55
    v_fma_f32 v45, -v44, v44, v45
    v_add_f32 v45, s69, abs(v45)
    v_pk_add_f32 v[42:43], v[42:43], v[44:45] op_sel:[0,0] op_sel_hi:[1,0] neg_lo:[0,1] neg_hi:[0,1]
    v_rsq_f32 v45, v45
    s_nop 0
    v_pk_mul_f32 v[42:43], v[42:43], v[44:45] op_sel:[0,1] op_sel_hi:[1,1]
    v_cvt_pk_bf16_f32 v42, 0, v42
    v_cvt_pk_bf16_f32 v43, 0, v43
    v_bfe_u32 v2, v42, 15, 16
    v_ashrrev_i32 v4, 31, v42
    v_bfe_u32 v3, v43, 15, 16
    v_ashrrev_i32 v5, 31, v43
    v_cmp_eq_u32 s[16:17], 0, v2
    v_and_b32 v4, v245, v4
    v_cmp_eq_u32 s[18:19], 0, v3
    v_and_b32 v5, v245, v5
    v_add3_u32 v4, v2, v4, s68
    v_add3_u32 v5, v3, v5, s68
    v_cndmask_b32 v4, v4, v247, s[16:17]
    ds_read_u16_d16_hi v16, v4
    v_cndmask_b32 v5, v5, v247, s[18:19]
    ds_read_u16_d16_hi v17, v5
    v_subrev_u32 v2, 28160, v2
    v_cmp_gt_u32 s[20:21], v245, v2
    v_subrev_u32 v3, 28160, v3
    v_cmp_gt_u32 s[22:23], v245, v3
    s_or_b64 s[20:21], s[20:21], s[16:17]
    s_or_b64 s[22:23], s[22:23], s[18:19]
    s_waitcnt lgkmcnt(0)
    v_pk_fma_f32 v[16:17], v[16:17], v[236:237], v[240:241]
    v_cvt_pk_bf16_f32 v16, v16, v17
    v_mov_b32 v17, v16
    s_and_b64 s[16:17], s[20:21], s[22:23]
    s_not_b64 s[16:17], s[16:17]
    v_permlane32_swap_b32 v16, v17
    s_cbranch_scc1 L_slowout
    v_perm_b32 v16, v17, v16, v231
    s_nop 1
    v_mov_b32_dpp v17, v16 quad_perm:[1,1,1,1] row_mask:0xf bank_mask:0xf
    v_mov_b32_dpp v18, v16 quad_perm:[2,2,2,2] row_mask:0xf bank_mask:0xf
    v_mov_b32_dpp v19, v16 quad_perm:[3,3,3,3] row_mask:0xf bank_mask:0xf
    s_mov_b64 exec, s[70:71]
    global_store_dwordx4 v228, v[16:19], s[40:41] sc0 sc1
    s_branch L_listed
L_slowout:
    v_permlane32_swap_b32 v16, v17
    s_mov_b64 exec, s[20:21]
    global_store_short v238, v16, s[40:41]
    s_mov_b64 exec, s[22:23]
    global_store_short_d16_hi v238, v16, s[40:41] offset:16
    s_not_b64 exec, s[20:21]
    v_mov_b32 v2, 1
    ds_add_rtn_u32 v2, v13, v2 offset:44
    v_mov_b32 v4, v42
    v_mov_b32 v5, v240
    v_mov_b32 v6, v236
    v_add_u32 v7, 0, v238
    s_waitcnt lgkmcnt(0)
    v_lshlrev_b32 v2, 4, v2
    ds_write_b128 v2, v[4:7] offset:0
    s_not_b64 exec, s[22:23]
    v_mov_b32 v2, 1
    ds_add_rtn_u32 v2, v13, v2 offset:44
    v_mov_b32 v4, v43
    v_mov_b32 v5, v241
    v_mov_b32 v6, v237
    v_add_u32 v7, 16, v238
    s_waitcnt lgkmcnt(0)
    v_lshlrev_b32 v2, 4, v2
    ds_write_b128 v2, v[4:7] offset:0
    s_waitcnt lgkmcnt(0)
L_listed:
    s_mov_b64 exec, -1
L_wait67:
    s_barrier
    s_cmp_lt_u32 s3, 6
    s_cbranch_scc1 L_last
    ds_read_b32 v2, v13 offset:44
    s_waitcnt lgkmcnt(0)
    v_readfirstlane_b32 s69, v2
    s_nop 0
    s_cmp_eq_u32 s69, 0
    s_cbranch_scc1 L_fin
    s_sub_u32 s3, s3, 4
    s_mov_b32 s65, 1
    s_mov_b32 s76, 0
L_batch:
    v_and_b32 v2, 3, v0
    v_add_u32 v2, s76, v2
    v_cmp_gt_u32 s[78:79], s69, v2
    s_sub_u32 s8, s69, 1
    v_min_u32 v2, s8, v2
    v_lshlrev_b32 v2, 4, v2
    ds_read_b128 v[236:239], v2 offset:0
    s_waitcnt lgkmcnt(0)
    v_mov_b32 v12, v236
    s_branch L_mlp
L_output:
    v_fma_f32 v16, v238, v16, v237
    v_cvt_pk_bf16_f32 v16, v16, v16
    s_and_b64 exec, s[78:79], 15
    global_store_short v239, v16, s[40:41]
    s_mov_b64 exec, -1
L_batchdone:
    s_barrier
    s_add_u32 s76, s76, 4
    s_cmp_lt_u32 s76, s69
    s_cbranch_scc1 L_batch
    s_branch L_fin
L_t1_retry:
    s_mov_b64 exec, s[16:17]
    buffer_load_dwordx4 v[160:163], v2, s[56:59], s74 offen offset:0 sc1
    s_mov_b64 exec, s[18:19]
    buffer_load_dwordx4 v[164:167], v2, s[56:59], s74 offen offset:512 sc1
    s_mov_b64 exec, s[20:21]
    buffer_load_dwordx4 v[168:171], v2, s[56:59], s74 offen offset:1024 sc1
    s_mov_b64 exec, s[22:23]
    buffer_load_dwordx4 v[172:175], v2, s[56:59], s74 offen offset:1536 sc1
    s_mov_b64 exec, s[24:25]
    buffer_load_dwordx4 v[176:179], v2, s[56:59], s74 offen offset:2048 sc1
    s_mov_b64 exec, s[26:27]
    buffer_load_dwordx4 v[180:183], v2, s[56:59], s74 offen offset:2560 sc1
    s_mov_b64 exec, s[36:37]
    buffer_load_dwordx4 v[184:187], v2, s[56:59], s74 offen offset:3072 sc1
    s_mov_b64 exec, s[38:39]
    buffer_load_dwordx4 v[188:191], v2, s[56:59], s74 offen offset:3584 sc1
    s_mov_b64 exec, -1
    s_add_u32 s14, s14, 1
    s_cmp_lt_u32 s14, 262144
    s_cbranch_scc1 L_t1_chk
    s_waitcnt vmcnt(0)
    s_branch L_t1_done
L_pref:
    s_and_b32 s8, s2, 7
    s_cmp_lg_u32 s8, 0
    s_cbranch_scc1 L_fin
    s_waitcnt vmcnt(0)
    s_barrier
    v_lshlrev_b32 v1, 7, v0
    s_lshl_b32 s8, s3, 13
    s_add_u32 s8, s8, 786432
    buffer_load_dword v2, v1, s[56:59], s8 offen sc1
    s_branch L_fin
L_t2_retry:
    s_mov_b64 exec, s[16:17]
    buffer_load_dwordx4 v[16:19], v244, s[56:59], s75 offen offset:0 sc1
    s_mov_b64 exec, s[18:19]
    buffer_load_dwordx4 v[20:23], v244, s[56:59], s75 offen offset:2048 sc1
    s_mov_b64 exec, s[20:21]
    buffer_load_dwordx4 v[24:27], v244, s[56:59], s73 offen offset:0 sc1
    s_mov_b64 exec, s[22:23]
    buffer_load_dwordx4 v[28:31], v244, s[56:59], s73 offen offset:2048 sc1
    s_mov_b64 exec, -1
    s_add_u32 s14, s14, 1
    s_cmp_lt_u32 s14, 262144
    s_cbranch_scc1 L_t2_chk
    s_waitcnt vmcnt(0)
    s_branch L_t2_done
L_early:
    s_cmp_ge_u32 s3, 6
    s_cbranch_scc1 L_wait67
L_last:
    s_cmp_lg_u32 s3, 4
    s_cbranch_scc1 L_fin
    s_cmp_lg_u32 s2, 0
    s_cbranch_scc1 L_fin
    s_mov_b64 exec, 1
    v_mov_b32 v16, s46
    s_mov_b32 s8, 167936
    buffer_store_dword v16, off, s[56:59], s8 sc0 sc1
L_fin:
L_end:
    s_endpgm
.section .rodata,"a"
.p2align 6
.amdhsa_kernel adaLN_cond__gqa_block_cached__mixer_token_mlp__decode_kernel
.amdhsa_next_free_vgpr 256
.amdhsa_next_free_sgpr 102
.amdhsa_accum_offset 256
.amdhsa_group_segment_fixed_size 0
.amdhsa_kernarg_size 120
.amdhsa_user_sgpr_count 2
.amdhsa_user_sgpr_kernarg_segment_ptr 1
.amdhsa_system_sgpr_workgroup_id_x 1
.amdhsa_float_denorm_mode_32 3
.end_amdhsa_kernel
```
